```python
import torch

def _softmax(x, axis=-1):
    return torch.softmax(x, dim=axis)
def _gelu(x):
    return torch.nn.functional.gelu(x, approximate="tanh")
def _silu(x):
    return torch.nn.functional.silu(x)
def _sigmoid(x):
    return torch.sigmoid(x)
def _layernorm(x, axis=-1, eps=1e-5):
    m = x.mean(dim=axis, keepdim=True)
    v = x.var(dim=axis, keepdim=True, unbiased=False)
    return (x - m) / torch.sqrt(v + eps)
def _scatter_add(tgt, idx, src, axis=0):
    return tgt.clone().index_add_(axis, idx, src)
def _segment_sum(src, seg, n):
    out = torch.zeros((n,) + src.shape[1:], dtype=src.dtype)
    return out.index_add_(0, seg, src)
def _pad(x, pw):
    flat = tuple(v for pair in reversed(pw) for v in pair)
    return torch.nn.functional.pad(x, flat)

kernel_name = 'gated_mix__ssm_conv_s4d__linear_attn_block__prompt'

def setup_inputs():

    _w = (lambda a: (lambda t: t.to(torch.bfloat16) if t.is_floating_point() else t)(torch.as_tensor(a)))
    def _A_setup():
        Bsz, L, D, N = 1, 2048, 1024, 128
        return {
            "u": _w((lambda *s: torch.randn(*s, dtype=torch.bfloat16) * 0.05)(Bsz, L, D)),
            "log_A_real": _w((lambda *s: torch.randn(*s, dtype=torch.bfloat16) * 3.2)(D, N) * 0.5),
            "A_imag": _w((lambda *s: torch.randn(*s, dtype=torch.bfloat16) * 0.05)(D, N) * 3.14),
            "C_real": _w((lambda *s: torch.randn(*s, dtype=torch.bfloat16) * 0.8)(D, N) / N ** 0.5),
            "C_imag": _w((lambda *s: torch.randn(*s, dtype=torch.bfloat16) * 0.8)(D, N) / N ** 0.5),
            "log_dt": _w((lambda *s: torch.randn(*s, dtype=torch.bfloat16) * 0.05)(D) * 0.5 - 4.0),
            "D_skip": _w((lambda *s: torch.randn(*s, dtype=torch.bfloat16) * 0.1)(D)),
        }
    _A_in = _A_setup()

    def _B_setup():
        B, S, D = 1, 2048, 1024
        return {
            "x": _w((lambda *s: torch.randn(*s, dtype=torch.bfloat16) * 0.05)(B, S, D)),
            "wqkv": _w((lambda *s: torch.randn(*s, dtype=torch.bfloat16) * 0.8)(D, 3 * D)),
            "wo": _w((lambda *s: torch.randn(*s, dtype=torch.bfloat16) * 0.05)(D, D)),
        }
    _B_in = _B_setup()

    return {
        "A_u": _A_in["u"],
        "A_log_A_real": _A_in["log_A_real"],
        "A_A_imag": _A_in["A_imag"],
        "A_C_real": _A_in["C_real"],
        "A_C_imag": _A_in["C_imag"],
        "A_log_dt": _A_in["log_dt"],
        "A_D_skip": _A_in["D_skip"],
        "B_x": _B_in["x"],
        "B_wqkv": _B_in["wqkv"],
        "B_wo": _B_in["wo"],
        "gate_w": _w((lambda *s: torch.randn(*s, dtype=torch.bfloat16) * 0.05)(1024) * 16.0),
    }

def reference(A_u, A_log_A_real, A_A_imag, A_C_real, A_C_imag, A_log_dt, A_D_skip, B_x, B_wqkv, B_wo, gate_w):
    def _A_ref(u, log_A_real, A_imag, C_real, C_imag, log_dt, D_skip):
        L = u.shape[1]
        dt = torch.exp(log_dt)
        A = -torch.exp(log_A_real) + 1j * A_imag
        C = (C_real + 1j * C_imag) * dt[:, None]
        pos = (lambda x, dt: x.to(dt))(torch.arange(L), log_dt.dtype)
        P = torch.exp((A * dt[:, None])[:, :, None] * pos[None, None, :])
        K = 2.0 * torch.einsum("dn,dnl->dl", C, P).real
        L2 = 2 * L
        u_t = (lambda x, *d: x.permute(*d))(u, 0, 2, 1)
        Kf = (lambda x, *a, **k: torch.fft.rfft(x.float(), *a, **k))(K, L2)
        Uf = (lambda x, *a, **k: torch.fft.rfft(x.float(), *a, **k))(u_t, L2)
        y = (lambda x, *a, **k: torch.fft.irfft(x, *a, **k).to(torch.bfloat16))(Uf * Kf[None, :, :], L2)[:, :, :L]
        y = (lambda x, *d: x.permute(*d))(y, 0, 2, 1)
        return y + u * D_skip[None, None, :]

    def _B_ref(x, wqkv, wo):
        B, S, D = x.shape
        H = 32; Dh = D // H
        qkv = (lambda x, *d: x.permute(*d))((x @ wqkv).reshape(B, S, 3, H, Dh), 2, 0, 3, 1, 4)
        q, k, v = qkv[0], qkv[1], qkv[2]
        phi = lambda t: torch.where(t > 0, t + 1, torch.exp(t)) + 1e-6
        pq, pk = phi(q), phi(k)
        kv = torch.einsum("bhsd,bhse->bhde", pk, v)
        z = torch.einsum("bhsd->bhd", pk)
        num = torch.einsum("bhqd,bhde->bhqe", pq, kv)
        den = torch.einsum("bhqd,bhd->bhq", pq, z)[..., None] + 1e-6
        o = num / den
        return (lambda x, *d: x.permute(*d))(o, 0, 2, 1, 3).reshape(B, S, D) @ wo

    x = A_u
    g = _sigmoid((x * gate_w).sum(-1, keepdims=True))
    a = _A_ref(x, A_log_A_real, A_A_imag, A_C_real, A_C_imag, A_log_dt, A_D_skip)
    b = _B_ref(x, B_wqkv, B_wo)
    return g * a + (1 - g) * b
```

```asm
; @launch grid=(256,1,1) block=(512,1,1) lds=163840
.amdgcn_target "amdgcn-amd-amdhsa--gfx950"
.text
.globl gated_mix__ssm_conv_s4d__linear_attn_block__prompt_kernel
.p2align 8
.type gated_mix__ssm_conv_s4d__linear_attn_block__prompt_kernel,@function
gated_mix__ssm_conv_s4d__linear_attn_block__prompt_kernel:
    s_cmp_ge_u32 s2, 256
    s_cbranch_scc1 L_end
    s_load_dwordx16 s[4:19], s[0:1], 0
    s_load_dwordx8 s[20:27], s[0:1], 64
    s_load_dwordx4 s[28:31], s[0:1], 96
    v_lshrrev_b32 v1, 6, v0
    v_and_b32 v0, 63, v0
    s_and_b32 s40, s2, 7
    v_readfirstlane_b32 s3, v1
    s_lshr_b32 s41, s2, 3
    s_and_b32 s36, s40, 1
    s_lshl_b32 s36, s36, 3
    s_and_b32 s42, s41, 7
    s_add_u32 s36, s36, s42
    s_lshr_b32 s37, s40, 1
    s_lshl_b32 s37, s37, 2
    s_lshr_b32 s42, s41, 3
    s_add_u32 s37, s37, s42
    s_and_b32 s38, s40, 3
    s_lshl_b32 s38, s38, 2
    s_and_b32 s42, s41, 3
    s_add_u32 s38, s38, s42
    s_lshr_b32 s39, s40, 2
    s_lshl_b32 s39, s39, 3
    s_lshr_b32 s42, s41, 2
    s_add_u32 s39, s39, s42
    s_mul_i32 s44, s38, 0
    s_add_u32 s44, s44, s39
    s_lshl_b32 s44, s44, 1
    s_and_b32 s44, s44, 0
    s_cmp_lt_u32 s3, 4
    s_cbranch_scc1 L_compute
    s_sub_u32 s68, s3, 4
    v_lshrrev_b32 v1, 3, v0
    v_lshlrev_b32 v3, 11, v1
    v_mul_u32_u24 v5, 6144, v1
    v_lshrrev_b32 v1, 4, v0
    v_and_b32 v2, 7, v0
    v_xor_b32 v2, v2, v1
    v_lshl_add_u32 v3, v2, 4, v3
    v_and_b32 v1, 1, v1
    v_lshlrev_b32 v1, 1, v1
    v_and_b32 v2, 7, v0
    v_xor_b32 v2, v2, v1
    v_lshl_add_u32 v5, v2, 4, v5
    s_lshl_b32 s40, s36, 18
    s_lshl_b32 s41, s68, 16
    s_add_u32 s40, s40, s41
    v_add_u32 v3, s40, v3
    v_xor_b32 v4, 64, v3
    s_lshl_b32 s40, s37, 7
    s_mul_i32 s41, s68, 98304
    s_add_u32 s40, s40, s41
    v_add_u32 v5, s40, v5
    v_xor_b32 v6, 64, v5
    s_lshl_b32 s69, s68, 12
    s_lshl_b32 s70, s68, 11
    s_add_u32 s70, s70, 16384
    s_lshl_b32 s71, s2, 2
    s_add_u32 s71, s71, s68
    s_mov_b32 s50, 4194304
    s_mov_b32 s51, 0x20000
    s_mov_b32 s54, 6291456
    s_mov_b32 s55, 0x20000
    s_mov_b32 s82, 0
    s_mov_b32 s83, 15360
    s_mov_b32 s84, 30720
    s_mov_b32 s85, 46080
    s_mov_b32 s86, 0
    s_mov_b32 s87, 48128
    s_mov_b32 s88, 2048
    s_mov_b32 s89, 50176
    s_mov_b32 s90, 4096
    s_mov_b32 s91, 52224
    s_and_b32 s78, s37, 12
    s_lshl_b32 s40, s78, 7
    s_mul_i32 s41, s78, 393216
    s_waitcnt lgkmcnt(0)
    s_add_u32 s48, s4, s40
    s_addc_u32 s49, s5, 0
    s_add_u32 s52, s20, s41
    s_addc_u32 s53, s21, 0
    s_add_u32 m0, s69, 40960
    s_nop 0
    buffer_load_dwordx4 v3, s[48:51], s82 offen offset:0 lds
    buffer_load_dwordx4 v4, s[48:51], s83 offen offset:1024 lds
    buffer_load_dwordx4 v3, s[48:51], s84 offen offset:2048 lds
    buffer_load_dwordx4 v4, s[48:51], s85 offen offset:3072 lds
    s_add_u32 m0, s70, 40960
    s_nop 0
    buffer_load_dwordx4 v5, s[52:55], s86 offen offset:0 lds
    buffer_load_dwordx4 v6, s[52:55], s87 offen offset:1024 lds
    s_add_u32 m0, s70, 49152
    s_nop 0
    buffer_load_dwordx4 v5, s[52:55], s88 offen offset:0 lds
    buffer_load_dwordx4 v6, s[52:55], s89 offen offset:1024 lds
    s_and_b32 s40, s36, 7
    s_mul_i32 s40, s40, 196608
    s_and_b32 s41, s37, 3
    s_lshl_b32 s42, s41, 11
    s_add_u32 s40, s40, s42
    s_or_b32 s42, s37, 3
    s_lshl_b32 s42, s42, 7
    s_add_u32 s40, s40, s42
    v_and_b32 v1, 31, v0
    v_mul_u32_u24 v7, 6144, v1
    v_add_u32 v7, s40, v7
    s_and_b32 s40, s37, 7
    s_cmp_lt_u32 s40, 3
    s_cselect_b32 s58, 6291456, 0
    s_mov_b64 s[56:57], s[20:21]
    s_mov_b32 s59, 0x20000
    s_cmp_eq_u32 s68, 0
    s_cbranch_scc1 L_pfset
    s_lshl_b32 s40, s36, 2
    s_add_u32 s40, s40, s41
    s_mul_i32 s42, s40, 24576
    s_lshl_b32 s75, s78, 7
    s_add_u32 s42, s42, s75
    v_lshrrev_b32 v2, 4, v0
    v_mul_u32_u24 v7, 6144, v2
    v_bfe_u32 v2, v0, 2, 2
    v_min_u32 v2, 2, v2
    v_lshl_add_u32 v7, v2, 11, v7
    v_and_b32 v2, 3, v0
    v_lshl_add_u32 v7, v2, 7, v7
    v_add_u32 v7, s42, v7
    s_mov_b32 s58, 6291456
    s_cmp_eq_u32 s68, 2
    s_cbranch_scc1 L_pfset
    s_lshl_b32 s40, s40, 16
    v_lshl_add_u32 v7, v1, 11, s40
    s_mov_b64 s[56:57], s[4:5]
    s_mov_b32 s58, 4194304
    s_cmp_eq_u32 s68, 1
    s_cbranch_scc1 L_pfset
    s_lshl_b32 s40, s2, 13
    v_lshl_add_u32 v7, v0, 7, s40
    s_mov_b64 s[56:57], s[22:23]
    s_mov_b32 s58, 2097152
L_pfset:
    s_and_b32 s40, s37, 3
    s_lshl_b32 s41, s36, 2
    s_add_u32 s40, s40, s41
    s_and_b32 s40, s40, 63
    s_mul_i32 s79, s40, 6144
    s_add_u32 s40, s78, s68
    s_lshl_b32 s40, s40, 7
    s_add_u32 s79, s79, s40
    s_lshl_b32 s80, s71, 11
    s_mov_b32 s32, s30
    s_mov_b32 s33, s31
    s_mov_b32 s34, 0x10000000
    s_mov_b32 s35, 0x20000
    s_mul_i32 s72, s68, 10240
    s_add_u32 s72, s72, 40960
    s_mul_i32 s73, s68, 4608
    s_add_u32 s73, s73, 0
    v_lshrrev_b32 v1, 4, v0
    v_lshlrev_b32 v178, 10, v1
    v_bfe_u32 v2, v0, 2, 2
    v_lshl_add_u32 v178, v2, 7, v178
    v_lshlrev_b32 v16, 14, v2
    v_lshl_add_u32 v16, v1, 6, v16
    v_and_b32 v1, 1, v1
    v_lshl_add_u32 v178, v1, 6, v178
    v_bfe_u32 v1, v0, 1, 1
    v_bfe_u32 v2, v0, 3, 1
    v_xor_b32 v1, v1, v2
    v_lshl_add_u32 v178, v1, 4, v178
    v_and_b32 v1, 1, v0
    v_lshl_add_u32 v178, v1, 3, v178
    v_and_b32 v1, 3, v0
    v_lshl_add_u32 v16, v1, 4, v16
    v_lshlrev_b32 v21, 6, v1
    s_and_b32 s40, s37, 3
    s_mul_i32 s41, s40, 43
    s_lshr_b32 s41, s41, 7
    s_mul_i32 s41, s41, 3
    s_sub_u32 s40, s40, s41
    s_mul_i32 s40, s40, 40960
    s_add_u32 s40, s40, s69
    s_add_u32 s40, s40, 40960
    v_add_u32 v178, s40, v178
    v_xor_b32 v179, 32, v178
    v_xor_b32 v180, 64, v178
    v_xor_b32 v181, 96, v178
    s_lshl_b32 s40, s37, 18
    s_lshl_b32 s41, s36, 10
    s_add_u32 s40, s40, s41
    s_lshl_b32 s41, s68, 8
    s_add_u32 s40, s40, s41
    v_add_u32 v16, s40, v16
    s_lshl_b32 s40, s39, 4
    s_add_u32 s40, s40, s38
    s_mul_i32 s40, s40, 128
    s_add_u32 s40, s40, 15204352
    v_mov_b32 v18, s40
    v_mov_b32 v19, 0
    s_lshl_b32 s40, s2, 14
    s_lshl_b32 s41, s68, 4
    s_add_u32 m0, s70, 57344
    s_nop 0
    buffer_load_dwordx4 v5, s[52:55], s90 offen offset:0 lds
    s_add_u32 s40, s40, s41
    v_lshl_add_u32 v22, v0, 6, s40
    v_lshrrev_b32 v1, 3, v0
    v_lshlrev_b32 v24, 11, v1
    v_lshrrev_b32 v1, 4, v0
    v_lshlrev_b32 v1, 1, v1
    v_and_b32 v2, 7, v0
    v_xor_b32 v1, v1, v2
    buffer_load_dwordx4 v6, s[52:55], s91 offen offset:1024 lds
    s_add_u32 s48, s48, 128
    s_addc_u32 s49, s49, 0
    s_add_u32 s52, s52, 393216
    s_addc_u32 s53, s53, 0
    v_lshl_add_u32 v24, v1, 4, v24
    s_lshl_b32 s40, s39, 7
    v_add_u32 v24, s40, v24
    s_lshl_b32 s40, s68, 15
    v_add_u32 v23, s40, v24
    v_and_b32 v1, 15, v0
    v_lshrrev_b32 v2, 4, v0
    v_lshlrev_b32 v25, 5, v1
    s_add_u32 m0, s69, 81920
    s_nop 0
    buffer_load_dwordx4 v3, s[48:51], s82 offen offset:0 lds
    v_lshl_add_u32 v25, v2, 4, v25
    s_add_u32 s40, s73, 32
    v_add_u32 v25, s40, v25
    v_lshlrev_b32 v195, 3, v2
    v_sub_u32 v195, v1, v195
    v_lshlrev_b32 v32, 2, v2
    v_sub_u32 v32, v1, v32
    v_lshlrev_b32 v33, 2, v32
    buffer_load_dwordx4 v4, s[48:51], s83 offen offset:1024 lds
    s_add_u32 s40, s72, 2932
    v_add_u32 v33, s40, v33
    v_lshlrev_b32 v32, 3, v32
    s_add_u32 s40, s72, 2472
    v_add_u32 v32, s40, v32
    v_lshlrev_b32 v30, 4, v2
    v_lshrrev_b32 v2, 1, v1
    v_lshlrev_b32 v2, 2, v2
    buffer_load_dwordx4 v3, s[48:51], s84 offen offset:2048 lds
    v_sub_u32 v30, v30, v2
    v_and_b32 v1, 1, v1
    v_xor_b32 v1, 1, v1
    v_mul_u32_u24 v1, 1220, v1
    v_add_u32 v30, v30, v1
    s_add_u32 s40, s72, 28
    v_add_u32 v30, s40, v30
    v_add_u32 v31, 512, v30
    buffer_load_dwordx4 v4, s[48:51], s85 offen offset:3072 lds
    s_lshl_b32 s40, s68, 2
    s_add_u32 s40, s40, 0
    v_mov_b32 v26, s40
    v_mov_b32 v27, 1
    v_and_b32 v1, 31, v0
    v_mul_u32_u24 v28, 272, v1
    v_lshrrev_b32 v1, 5, v0
    v_lshl_add_u32 v28, v1, 4, v28
    s_add_u32 m0, s70, 81920
    s_nop 0
    buffer_load_dwordx4 v5, s[52:55], s86 offen offset:0 lds
    v_add_u32 v28, s72, v28
    v_lshlrev_b32 v1, 4, v0
    v_sub_u32 v29, 1072, v1
    v_add_u32 v29, s72, v29
    s_mov_b32 s76, 0xffff
    v_add_u32 v196, 27, v195
    v_mov_b32 v197, 7
    v_med3_i32 v196, v196, 0, 31
    buffer_load_dwordx4 v6, s[52:55], s87 offen offset:1024 lds
    v_lshlrev_b32 v196, v196, v197
    v_bfe_i32 v199, v196, 16, 1
    v_bfe_i32 v200, v196, 17, 1
    v_bfi_b32 v34, s76, v199, v200
    v_and_b32 v34, 1065369472, v34
    v_bfe_i32 v199, v196, 18, 1
    v_bfe_i32 v200, v196, 19, 1
    v_bfi_b32 v35, s76, v199, v200
    s_add_u32 m0, s70, 90112
    s_nop 0
    buffer_load_dwordx4 v5, s[52:55], s88 offen offset:0 lds
    v_and_b32 v35, 1065369472, v35
    v_bfe_i32 v199, v196, 20, 1
    v_bfe_i32 v200, v196, 21, 1
    v_bfi_b32 v36, s76, v199, v200
    v_and_b32 v36, 1065369472, v36
    v_bfe_i32 v199, v196, 22, 1
    v_bfe_i32 v200, v196, 23, 1
    v_bfi_b32 v37, s76, v199, v200
    buffer_load_dwordx4 v6, s[52:55], s89 offen offset:1024 lds
    v_and_b32 v37, 1065369472, v37
    v_add_u32 v196, 22, v195
    v_mov_b32 v197, 31
    v_med3_i32 v196, v196, 0, 31
    v_lshlrev_b32 v196, v196, v197
    v_bfe_i32 v199, v196, 16, 1
    v_bfe_i32 v200, v196, 17, 1
    v_bfi_b32 v38, s76, v199, v200
    s_waitcnt vmcnt(8)
    s_barrier
    s_and_b32 s74, s37, 3
    s_cmp_lg_u32 s74, 0
    s_cbranch_scc1 L_utr_1
    ds_read_b64_tr_b16 v[162:163], v178 offset:0
    ds_read_b64_tr_b16 v[164:165], v179 offset:512
    ds_read_b64_tr_b16 v[166:167], v179 offset:0
    ds_read_b64_tr_b16 v[168:169], v178 offset:512
    ds_read_b64_tr_b16 v[170:171], v180 offset:0
    ds_read_b64_tr_b16 v[172:173], v181 offset:512
    ds_read_b64_tr_b16 v[174:175], v181 offset:0
    ds_read_b64_tr_b16 v[176:177], v180 offset:512
    s_waitcnt lgkmcnt(0)
L_utr_1:
    s_add_u32 m0, s70, 98304
    s_nop 0
    buffer_load_dwordx4 v5, s[52:55], s90 offen offset:0 lds
    v_and_b32 v38, 1065369472, v38
    v_bfe_i32 v199, v196, 18, 1
    v_bfe_i32 v200, v196, 19, 1
    buffer_load_dwordx4 v6, s[52:55], s91 offen offset:1024 lds
    s_add_u32 s48, s48, 128
    s_addc_u32 s49, s49, 0
    s_add_u32 s52, s52, 393216
    s_addc_u32 s53, s53, 0
    v_bfi_b32 v39, s76, v199, v200
    v_and_b32 v39, 1065369472, v39
    v_bfe_i32 v199, v196, 20, 1
    v_bfe_i32 v200, v196, 21, 1
    s_lshl_b32 s74, s71, 8
    v_lshl_add_u32 v20, v0, 2, s74
    s_lshl_b32 s74, s71, 1
    v_mov_b32 v17, s74
    global_load_ushort v9, v17, s[14:15]
    global_load_dword v12, v20, s[6:7]
    global_load_dword v13, v20, s[8:9]
    global_load_dword v14, v20, s[10:11]
    global_load_dword v15, v20, s[12:13]
    global_load_ushort v10, v17, s[16:17]
    s_add_u32 m0, s69, 122880
    v_bfi_b32 v40, s76, v199, v200
    v_and_b32 v40, 1065369472, v40
    v_bfe_i32 v199, v196, 22, 1
    v_bfe_i32 v200, v196, 23, 1
    buffer_load_dwordx4 v3, s[48:51], s82 offen offset:0 lds
    v_bfi_b32 v41, s76, v199, v200
    v_and_b32 v41, 1065369472, v41
    v_add_u32 v196, 21, v195
    buffer_load_dwordx4 v4, s[48:51], s83 offen offset:1024 lds
    v_mov_b32 v197, 127
    v_med3_i32 v196, v196, 0, 31
    v_lshlrev_b32 v196, v196, v197
    v_bfe_i32 v199, v196, 16, 1
    buffer_load_dwordx4 v3, s[48:51], s84 offen offset:2048 lds
    v_bfe_i32 v200, v196, 17, 1
    v_bfi_b32 v42, s76, v199, v200
    v_and_b32 v42, 1065369472, v42
    v_bfe_i32 v199, v196, 18, 1
    buffer_load_dwordx4 v4, s[48:51], s85 offen offset:3072 lds
    s_add_u32 m0, s70, 122880
    v_bfe_i32 v200, v196, 19, 1
    v_bfi_b32 v43, s76, v199, v200
    v_and_b32 v43, 1065369472, v43
    v_bfe_i32 v199, v196, 20, 1
    buffer_load_dwordx4 v5, s[52:55], s86 offen offset:0 lds
    v_bfe_i32 v200, v196, 21, 1
    v_bfi_b32 v44, s76, v199, v200
    v_and_b32 v44, 1065369472, v44
    buffer_load_dwordx4 v6, s[52:55], s87 offen offset:1024 lds
    s_add_u32 m0, s70, 131072
    v_bfe_i32 v199, v196, 22, 1
    v_bfe_i32 v200, v196, 23, 1
    v_bfi_b32 v45, s76, v199, v200
    v_and_b32 v45, 1065369472, v45
    buffer_load_dwordx4 v5, s[52:55], s88 offen offset:0 lds
    v_add_u32 v196, 20, v195
    v_mov_b32 v197, 511
    v_med3_i32 v196, v196, 0, 31
    v_lshlrev_b32 v196, v196, v197
    buffer_load_dwordx4 v6, s[52:55], s89 offen offset:1024 lds
    s_add_u32 m0, s70, 139264
    v_bfe_i32 v199, v196, 16, 1
    v_bfe_i32 v200, v196, 17, 1
    v_bfi_b32 v46, s76, v199, v200
    buffer_load_dwordx4 v5, s[52:55], s90 offen offset:0 lds
    v_and_b32 v46, 1065369472, v46
    v_bfe_i32 v199, v196, 18, 1
    v_bfe_i32 v200, v196, 19, 1
    v_bfi_b32 v47, s76, v199, v200
    buffer_load_dwordx4 v6, s[52:55], s91 offen offset:1024 lds
    s_add_u32 s48, s48, 128
    s_addc_u32 s49, s49, 0
    s_add_u32 s52, s52, 393216
    s_addc_u32 s53, s53, 0
    v_and_b32 v47, 1065369472, v47
    v_bfe_i32 v199, v196, 20, 1
    v_bfe_i32 v200, v196, 21, 1
    v_bfi_b32 v48, s76, v199, v200
    s_add_u32 s74, s78, 4
    s_and_b32 s74, s74, 15
    s_lshl_b32 s75, s74, 7
    s_add_u32 s75, s75, 384
    s_bitcmp1_b32 s74, 2
    s_cselect_b32 s75, 0x7ff00000, s75
    s_mul_i32 s74, s74, 393216
    s_cmp_eq_u32 s68, 3
    s_cselect_b32 s75, 0, s75
    s_bitcmp0_b32 s68, 0
    s_cselect_b32 s75, s74, s75
    s_mov_b32 s74, 7
    s_bitcmp1_b32 s74, s68
    s_cselect_b32 s75, s75, 0x7ff00000
    buffer_load_dword v8, v7, s[56:59], s75 offen
    v_and_b32 v48, 1065369472, v48
    v_bfe_i32 v199, v196, 22, 1
    v_bfe_i32 v200, v196, 23, 1
    v_bfi_b32 v49, s76, v199, v200
    s_waitcnt vmcnt(17)
    s_barrier
    s_and_b32 s74, s37, 3
    s_cmp_lg_u32 s74, 1
    s_cbranch_scc1 L_utr_2
    ds_read_b64_tr_b16 v[162:163], v178 offset:0
    ds_read_b64_tr_b16 v[164:165], v179 offset:512
    ds_read_b64_tr_b16 v[166:167], v179 offset:0
    ds_read_b64_tr_b16 v[168:169], v178 offset:512
    ds_read_b64_tr_b16 v[170:171], v180 offset:0
    ds_read_b64_tr_b16 v[172:173], v181 offset:512
    ds_read_b64_tr_b16 v[174:175], v181 offset:0
    ds_read_b64_tr_b16 v[176:177], v180 offset:512
    s_waitcnt lgkmcnt(0)
L_utr_2:
    s_add_u32 m0, s69, 40960
    s_nop 0
    buffer_load_dwordx4 v3, s[48:51], s82 offen offset:0 lds
    v_and_b32 v49, 1065369472, v49
    v_add_u32 v196, 28, v195
    v_mov_b32 v197, 3
    v_med3_i32 v196, v196, 0, 31
    v_lshlrev_b32 v196, v196, v197
    buffer_load_dwordx4 v4, s[48:51], s83 offen offset:1024 lds
    v_bfe_i32 v199, v196, 16, 1
    v_bfe_i32 v200, v196, 17, 1
    v_bfi_b32 v50, s76, v199, v200
    v_bfe_i32 v199, v196, 18, 1
    v_bfe_i32 v200, v196, 19, 1
    buffer_load_dwordx4 v3, s[48:51], s84 offen offset:2048 lds
    v_bfi_b32 v51, s76, v199, v200
    v_bfe_i32 v199, v196, 20, 1
    v_bfe_i32 v200, v196, 21, 1
    v_bfi_b32 v52, s76, v199, v200
    v_bfe_i32 v199, v196, 22, 1
    buffer_load_dwordx4 v4, s[48:51], s85 offen offset:3072 lds
    s_add_u32 m0, s70, 40960
    v_bfe_i32 v200, v196, 23, 1
    v_bfi_b32 v53, s76, v199, v200
    s_waitcnt vmcnt(20)
    v_lshlrev_b32 v194, 16, v9
    v_mul_f32 v194, 1069066811, v194
    v_exp_f32 v194, v194
    buffer_load_dwordx4 v5, s[52:55], s86 offen offset:0 lds
    s_waitcnt vmcnt(16)
    v_lshlrev_b32 v10, 16, v10
    v_cvt_pk_bf16_f32 v194, v194, v194
    v_lshlrev_b32 v194, 16, v194
    v_lshlrev_b32 v195, 16, v12
    v_mul_f32 v195, 1069066811, v195
    v_exp_f32 v195, v195
    buffer_load_dwordx4 v6, s[52:55], s87 offen offset:1024 lds
    s_add_u32 m0, s70, 49152
    v_lshlrev_b32 v196, 16, v13
    v_lshlrev_b32 v197, 16, v14
    v_cvt_pk_bf16_f32 v195, v195, v195
    v_lshlrev_b32 v198, 16, v15
    v_lshlrev_b32 v195, 16, v195
    buffer_load_dwordx4 v5, s[52:55], s88 offen offset:0 lds
    v_mul_f32 v195, v195, v194
    v_mul_f32 v196, v196, v194
    v_mul_f32 v197, v197, v194
    v_mul_f32 v198, v198, v194
    v_mul_f32 v195, 3216550459, v195
    buffer_load_dwordx4 v6, s[52:55], s89 offen offset:1024 lds
    s_add_u32 m0, s70, 57344
    v_mul_f32 v196, 1042479491, v196
    v_add_f32 v197, v197, v197
    v_add_f32 v198, v198, v198
    v_mul_f32 v199, 1090519040, v195
    v_mul_f32 v200, 1090519040, v196
    buffer_load_dwordx4 v5, s[52:55], s90 offen offset:0 lds
    v_exp_f32 v199, v199
    v_fract_f32 v200, v200
    v_cos_f32 v207, v200
    v_sin_f32 v208, v200
    v_mul_f32 v207, v199, v207
    buffer_load_dwordx4 v6, s[52:55], s91 offen offset:1024 lds
    s_add_u32 s48, s48, 128
    s_addc_u32 s49, s49, 0
    s_add_u32 s52, s52, 393216
    s_addc_u32 s53, s53, 0
    s_cmp_eq_u32 s78, 12
    s_cselect_b64 s[48:49], s[4:5], s[48:49]
    s_cselect_b64 s[52:53], s[20:21], s[52:53]
    v_mul_f32 v208, v199, v208
    v_sub_f32 v209, 0, v208
    v_mul_f32 v199, 1065353216, v195
    v_mul_f32 v200, 1065353216, v196
    v_exp_f32 v199, v199
    v_fract_f32 v200, v200
    s_waitcnt vmcnt(11)
    s_barrier
    s_and_b32 s74, s37, 3
    s_cmp_lg_u32 s74, 2
    s_cbranch_scc1 L_utr_3
    ds_read_b64_tr_b16 v[162:163], v178 offset:0
    ds_read_b64_tr_b16 v[164:165], v179 offset:512
    ds_read_b64_tr_b16 v[166:167], v179 offset:0
    ds_read_b64_tr_b16 v[168:169], v178 offset:512
    ds_read_b64_tr_b16 v[170:171], v180 offset:0
    ds_read_b64_tr_b16 v[172:173], v181 offset:512
    ds_read_b64_tr_b16 v[174:175], v181 offset:0
    ds_read_b64_tr_b16 v[176:177], v180 offset:512
    s_waitcnt lgkmcnt(0)
L_utr_3:
    s_add_u32 m0, s69, 81920
    s_nop 0
    buffer_load_dwordx4 v3, s[48:51], s82 offen offset:0 lds
    v_cos_f32 v201, v200
    v_sin_f32 v202, v200
    v_mul_f32 v201, v199, v201
    v_mul_f32 v202, v199, v202
    v_sub_f32 v203, 0, v202
    buffer_load_dwordx4 v4, s[48:51], s83 offen offset:1024 lds
    v_mul_f32 v199, 1132462080, v195
    v_mul_f32 v200, 1132462080, v196
    v_exp_f32 v199, v199
    v_fract_f32 v200, v200
    v_cos_f32 v210, v200
    buffer_load_dwordx4 v3, s[48:51], s84 offen offset:2048 lds
    v_sin_f32 v211, v200
    v_mul_f32 v210, v199, v210
    v_mul_f32 v211, v199, v211
    v_sub_f32 v212, 0, v211
    v_mul_f32 v204, v202, v203
    buffer_load_dwordx4 v4, s[48:51], s85 offen offset:3072 lds
    s_add_u32 m0, s70, 81920
    v_mul_f32 v205, v202, v201
    v_fmac_f32 v204, v201, v201
    v_fmac_f32 v205, v201, v202
    v_sub_f32 v206, 0, v205
    v_cvt_pk_bf16_f32 v55, v207, v208
    buffer_load_dwordx4 v5, s[52:55], s86 offen offset:0 lds
    v_mul_f32 v213, v208, v209
    v_mul_f32 v214, v208, v207
    v_fmac_f32 v213, v207, v207
    v_fmac_f32 v214, v207, v208
    v_cvt_pk_bf16_f32 v56, v213, v214
    buffer_load_dwordx4 v6, s[52:55], s87 offen offset:1024 lds
    s_add_u32 m0, s70, 90112
    v_mul_f32 v215, v214, v209
    v_mul_f32 v216, v214, v207
    v_fmac_f32 v215, v213, v207
    v_fmac_f32 v216, v213, v208
    v_cvt_pk_bf16_f32 v57, v215, v216
    buffer_load_dwordx4 v5, s[52:55], s88 offen offset:0 lds
    v_mul_f32 v213, v216, v209
    v_mul_f32 v214, v216, v207
    v_fmac_f32 v213, v215, v207
    v_fmac_f32 v214, v215, v208
    v_cvt_pk_bf16_f32 v58, v213, v214
    buffer_load_dwordx4 v6, s[52:55], s89 offen offset:1024 lds
    s_add_u32 m0, s70, 98304
    v_mul_f32 v215, v214, v209
    v_mul_f32 v216, v214, v207
    v_fmac_f32 v215, v213, v207
    v_fmac_f32 v216, v213, v208
    v_cvt_pk_bf16_f32 v59, v215, v216
    buffer_load_dwordx4 v5, s[52:55], s90 offen offset:0 lds
    v_mul_f32 v213, v216, v209
    v_mul_f32 v214, v216, v207
    v_fmac_f32 v213, v215, v207
    v_fmac_f32 v214, v215, v208
    v_cvt_pk_bf16_f32 v60, v213, v214
    buffer_load_dwordx4 v6, s[52:55], s91 offen offset:1024 lds
    s_add_u32 s48, s48, 128
    s_addc_u32 s49, s49, 0
    s_add_u32 s52, s52, 393216
    s_addc_u32 s53, s53, 0
    v_mul_f32 v215, v214, v209
    v_mul_f32 v216, v214, v207
    v_fmac_f32 v215, v213, v207
    v_fmac_f32 v216, v213, v208
    v_cvt_pk_bf16_f32 v61, v215, v216
    v_mul_f32 v213, v216, v209
    s_waitcnt vmcnt(10)
    s_barrier
    s_and_b32 s74, s37, 3
    s_cmp_lg_u32 s74, 3
    s_cbranch_scc1 L_utr_4
    ds_read_b64_tr_b16 v[162:163], v178 offset:0
    ds_read_b64_tr_b16 v[164:165], v179 offset:512
    ds_read_b64_tr_b16 v[166:167], v179 offset:0
    ds_read_b64_tr_b16 v[168:169], v178 offset:512
    ds_read_b64_tr_b16 v[170:171], v180 offset:0
    ds_read_b64_tr_b16 v[172:173], v181 offset:512
    ds_read_b64_tr_b16 v[174:175], v181 offset:0
    ds_read_b64_tr_b16 v[176:177], v180 offset:512
    s_waitcnt lgkmcnt(0)
L_utr_4:
    s_add_u32 m0, s69, 122880
    s_nop 0
    buffer_load_dwordx4 v3, s[48:51], s82 offen offset:0 lds
    v_mul_f32 v214, v216, v207
    v_fmac_f32 v213, v215, v207
    v_fmac_f32 v214, v215, v208
    v_cvt_pk_bf16_f32 v62, v213, v214
    buffer_load_dwordx4 v4, s[48:51], s83 offen offset:1024 lds
    v_mul_f32 v215, v214, v209
    v_mul_f32 v216, v214, v207
    v_fmac_f32 v215, v213, v207
    v_fmac_f32 v216, v213, v208
    buffer_load_dwordx4 v3, s[48:51], s84 offen offset:2048 lds
    v_cvt_pk_bf16_f32 v63, v215, v216
    v_mul_f32 v213, v216, v209
    v_mul_f32 v214, v216, v207
    v_fmac_f32 v213, v215, v207
    buffer_load_dwordx4 v4, s[48:51], s85 offen offset:3072 lds
    s_add_u32 m0, s70, 122880
    v_fmac_f32 v214, v215, v208
    v_cvt_pk_bf16_f32 v64, v213, v214
    v_mul_f32 v215, v214, v209
    v_mul_f32 v216, v214, v207
    buffer_load_dwordx4 v5, s[52:55], s86 offen offset:0 lds
    v_fmac_f32 v215, v213, v207
    v_fmac_f32 v216, v213, v208
    v_cvt_pk_bf16_f32 v65, v215, v216
    v_mul_f32 v213, v216, v209
    v_mul_f32 v214, v216, v207
    buffer_load_dwordx4 v6, s[52:55], s87 offen offset:1024 lds
    s_add_u32 m0, s70, 131072
    v_fmac_f32 v213, v215, v207
    v_fmac_f32 v214, v215, v208
    v_cvt_pk_bf16_f32 v66, v213, v214
    v_mul_f32 v215, v214, v209
    buffer_load_dwordx4 v5, s[52:55], s88 offen offset:0 lds
    v_mul_f32 v216, v214, v207
    v_fmac_f32 v215, v213, v207
    v_fmac_f32 v216, v213, v208
    v_cvt_pk_bf16_f32 v67, v215, v216
    buffer_load_dwordx4 v6, s[52:55], s89 offen offset:1024 lds
    s_add_u32 m0, s70, 139264
    v_mul_f32 v213, v216, v209
    v_mul_f32 v214, v216, v207
    v_fmac_f32 v213, v215, v207
    v_fmac_f32 v214, v215, v208
    buffer_load_dwordx4 v5, s[52:55], s90 offen offset:0 lds
    v_cvt_pk_bf16_f32 v68, v213, v214
    v_mul_f32 v215, v214, v209
    v_mul_f32 v216, v214, v207
    v_fmac_f32 v215, v213, v207
    buffer_load_dwordx4 v6, s[52:55], s91 offen offset:1024 lds
    s_add_u32 s48, s48, 128
    s_addc_u32 s49, s49, 0
    s_add_u32 s52, s52, 393216
    s_addc_u32 s53, s53, 0
    v_fmac_f32 v216, v213, v208
    v_cvt_pk_bf16_f32 v69, v215, v216
    v_mul_f32 v213, v216, v209
    v_mul_f32 v214, v216, v207
    v_fmac_f32 v213, v215, v207
    s_waitcnt vmcnt(10)
    s_barrier
    s_add_u32 m0, s69, 40960
    s_nop 0
    buffer_load_dwordx4 v3, s[48:51], s82 offen offset:0 lds
    v_fmac_f32 v214, v215, v208
    v_cvt_pk_bf16_f32 v70, v213, v214
    buffer_load_dwordx4 v4, s[48:51], s83 offen offset:1024 lds
    v_mul_f32 v215, v214, v209
    v_mul_f32 v216, v214, v207
    v_fmac_f32 v215, v213, v207
    buffer_load_dwordx4 v3, s[48:51], s84 offen offset:2048 lds
    v_fmac_f32 v216, v213, v208
    v_cvt_pk_bf16_f32 v71, v215, v216
    v_mul_f32 v213, v216, v209
    buffer_load_dwordx4 v4, s[48:51], s85 offen offset:3072 lds
    s_add_u32 m0, s70, 40960
    v_mul_f32 v214, v216, v207
    v_fmac_f32 v213, v215, v207
    buffer_load_dwordx4 v5, s[52:55], s86 offen offset:0 lds
    v_fmac_f32 v214, v215, v208
    v_cvt_pk_bf16_f32 v72, v213, v214
    v_mul_f32 v215, v214, v209
    buffer_load_dwordx4 v6, s[52:55], s87 offen offset:1024 lds
    s_add_u32 m0, s70, 49152
    v_mul_f32 v216, v214, v207
    v_fmac_f32 v215, v213, v207
    v_fmac_f32 v216, v213, v208
    buffer_load_dwordx4 v5, s[52:55], s88 offen offset:0 lds
    v_cvt_pk_bf16_f32 v73, v215, v216
    v_mul_f32 v213, v216, v209
    buffer_load_dwordx4 v6, s[52:55], s89 offen offset:1024 lds
    s_add_u32 m0, s70, 57344
    v_mul_f32 v214, v216, v207
    v_fmac_f32 v213, v215, v207
    v_fmac_f32 v214, v215, v208
    buffer_load_dwordx4 v5, s[52:55], s90 offen offset:0 lds
    v_cvt_pk_bf16_f32 v74, v213, v214
    v_mul_f32 v215, v214, v209
    v_mul_f32 v216, v214, v207
    buffer_load_dwordx4 v6, s[52:55], s91 offen offset:1024 lds
    s_add_u32 s48, s48, 128
    s_addc_u32 s49, s49, 0
    s_add_u32 s52, s52, 393216
    s_addc_u32 s53, s53, 0
    v_fmac_f32 v215, v213, v207
    v_fmac_f32 v216, v213, v208
    s_mov_b32 s74, 0
    buffer_store_dwordx4 v[162:165], v16, s[32:35], s74 offen sc1
    v_cvt_pk_bf16_f32 v75, v215, v216
    v_mul_f32 v213, v216, v209
    v_mul_f32 v214, v216, v207
    s_mov_b32 s74, 65536
    buffer_store_dwordx4 v[166:169], v16, s[32:35], s74 offen sc1
    v_fmac_f32 v213, v215, v207
    v_fmac_f32 v214, v215, v208
    v_cvt_pk_bf16_f32 v76, v213, v214
    s_add_u32 s74, s78, 8
    s_and_b32 s74, s74, 15
    s_lshl_b32 s75, s74, 7
    s_add_u32 s75, s75, 384
    s_bitcmp1_b32 s74, 2
    s_cselect_b32 s75, 0x7ff00000, s75
    s_mul_i32 s74, s74, 393216
    s_cmp_eq_u32 s68, 3
    s_cselect_b32 s75, 0, s75
    s_bitcmp0_b32 s68, 0
    s_cselect_b32 s75, s74, s75
    s_mov_b32 s74, 7
    s_bitcmp1_b32 s74, s68
    s_cselect_b32 s75, s75, 0x7ff00000
    buffer_load_dword v8, v7, s[56:59], s75 offen
    v_mul_f32 v215, v214, v209
    v_mul_f32 v216, v214, v207
    v_fmac_f32 v215, v213, v207
    s_waitcnt vmcnt(13)
    s_barrier
    s_add_u32 m0, s69, 81920
    s_nop 0
    buffer_load_dwordx4 v3, s[48:51], s82 offen offset:0 lds
    v_fmac_f32 v216, v213, v208
    v_cvt_pk_bf16_f32 v77, v215, v216
    buffer_load_dwordx4 v4, s[48:51], s83 offen offset:1024 lds
    v_mul_f32 v213, v216, v209
    v_mul_f32 v214, v216, v207
    v_fmac_f32 v213, v215, v207
    buffer_load_dwordx4 v3, s[48:51], s84 offen offset:2048 lds
    v_fmac_f32 v214, v215, v208
    v_cvt_pk_bf16_f32 v78, v213, v214
    v_mul_f32 v215, v214, v209
    buffer_load_dwordx4 v4, s[48:51], s85 offen offset:3072 lds
    s_add_u32 m0, s70, 81920
    v_mul_f32 v216, v214, v207
    v_fmac_f32 v215, v213, v207
    v_fmac_f32 v216, v213, v208
    buffer_load_dwordx4 v5, s[52:55], s86 offen offset:0 lds
    v_cvt_pk_bf16_f32 v79, v215, v216
    v_mul_f32 v213, v216, v209
    v_mul_f32 v214, v216, v207
    buffer_load_dwordx4 v6, s[52:55], s87 offen offset:1024 lds
    s_add_u32 m0, s70, 90112
    v_fmac_f32 v213, v215, v207
    v_fmac_f32 v214, v215, v208
    v_cvt_pk_bf16_f32 v80, v213, v214
    buffer_load_dwordx4 v5, s[52:55], s88 offen offset:0 lds
    v_mul_f32 v215, v214, v209
    v_mul_f32 v216, v214, v207
    buffer_load_dwordx4 v6, s[52:55], s89 offen offset:1024 lds
    s_add_u32 m0, s70, 98304
    v_fmac_f32 v215, v213, v207
    v_fmac_f32 v216, v213, v208
    v_cvt_pk_bf16_f32 v81, v215, v216
    buffer_load_dwordx4 v5, s[52:55], s90 offen offset:0 lds
    v_mul_f32 v213, v216, v209
    v_mul_f32 v214, v216, v207
    v_fmac_f32 v213, v215, v207
    buffer_load_dwordx4 v6, s[52:55], s91 offen offset:1024 lds
    s_add_u32 s48, s48, 128
    s_addc_u32 s49, s49, 0
    s_add_u32 s52, s52, 393216
    s_addc_u32 s53, s53, 0
    s_cmp_eq_u32 s78, 8
    s_cselect_b64 s[48:49], s[4:5], s[48:49]
    s_cselect_b64 s[52:53], s[20:21], s[52:53]
    v_fmac_f32 v214, v215, v208
    v_cvt_pk_bf16_f32 v82, v213, v214
    v_mul_f32 v215, v214, v209
    s_mov_b32 s74, 131072
    buffer_store_dwordx4 v[170:173], v16, s[32:35], s74 offen sc1
    v_mul_f32 v216, v214, v207
    v_fmac_f32 v215, v213, v207
    v_fmac_f32 v216, v213, v208
    s_mov_b32 s74, 196608
    buffer_store_dwordx4 v[174:177], v16, s[32:35], s74 offen sc1
    v_cvt_pk_bf16_f32 v83, v215, v216
    v_mul_f32 v213, v216, v209
    v_mul_f32 v214, v216, v207
    s_waitcnt vmcnt(15)
    s_barrier
    s_add_u32 m0, s69, 122880
    s_nop 0
    buffer_load_dwordx4 v3, s[48:51], s82 offen offset:0 lds
    v_fmac_f32 v213, v215, v207
    v_fmac_f32 v214, v215, v208
    v_cvt_pk_bf16_f32 v84, v213, v214
    v_mul_f32 v215, v214, v209
    buffer_load_dwordx4 v4, s[48:51], s83 offen offset:1024 lds
    v_mul_f32 v216, v214, v207
    v_fmac_f32 v215, v213, v207
    v_fmac_f32 v216, v213, v208
    v_cvt_pk_bf16_f32 v85, v215, v216
    buffer_load_dwordx4 v3, s[48:51], s84 offen offset:2048 lds
    v_cvt_pk_bf16_f32 v117, v197, -v198
    v_mul_f32 v213, v198, v203
    v_mul_f32 v214, v198, v201
    v_fmac_f32 v213, v197, v201
    buffer_load_dwordx4 v4, s[48:51], s85 offen offset:3072 lds
    s_add_u32 m0, s70, 122880
    v_fmac_f32 v214, v197, v202
    v_cvt_pk_bf16_f32 v118, v213, -v214
    v_mul_f32 v215, v214, v203
    v_mul_f32 v216, v214, v201
    v_fmac_f32 v215, v213, v201
    buffer_load_dwordx4 v5, s[52:55], s86 offen offset:0 lds
    v_fmac_f32 v216, v213, v202
    v_cvt_pk_bf16_f32 v119, v215, -v216
    v_mul_f32 v213, v216, v203
    v_mul_f32 v214, v216, v201
    buffer_load_dwordx4 v6, s[52:55], s87 offen offset:1024 lds
    s_add_u32 m0, s70, 131072
    v_fmac_f32 v213, v215, v201
    v_fmac_f32 v214, v215, v202
    v_cvt_pk_bf16_f32 v120, v213, -v214
    v_mul_f32 v215, v214, v203
    buffer_load_dwordx4 v5, s[52:55], s88 offen offset:0 lds
    v_mul_f32 v216, v214, v201
    v_fmac_f32 v215, v213, v201
    v_fmac_f32 v216, v213, v202
    v_cvt_pk_bf16_f32 v121, v215, -v216
    v_mul_f32 v213, v216, v203
    buffer_load_dwordx4 v6, s[52:55], s89 offen offset:1024 lds
    s_add_u32 m0, s70, 139264
    v_mul_f32 v214, v216, v201
    v_fmac_f32 v213, v215, v201
    v_fmac_f32 v214, v215, v202
    v_cvt_pk_bf16_f32 v122, v213, -v214
    buffer_load_dwordx4 v5, s[52:55], s90 offen offset:0 lds
    v_mul_f32 v215, v214, v203
    v_mul_f32 v216, v214, v201
    v_fmac_f32 v215, v213, v201
    v_fmac_f32 v216, v213, v202
    buffer_load_dwordx4 v6, s[52:55], s91 offen offset:1024 lds
    s_add_u32 s48, s48, 128
    s_addc_u32 s49, s49, 0
    s_add_u32 s52, s52, 393216
    s_addc_u32 s53, s53, 0
    v_cvt_pk_bf16_f32 v123, v215, -v216
    v_mul_f32 v213, v216, v203
    v_mul_f32 v214, v216, v201
    v_fmac_f32 v213, v215, v201
    v_fmac_f32 v214, v215, v202
    s_waitcnt vmcnt(12)
    s_barrier
    s_add_u32 m0, s69, 40960
    s_nop 0
    buffer_load_dwordx4 v3, s[48:51], s82 offen offset:0 lds
    v_cvt_pk_bf16_f32 v124, v213, -v214
    v_mul_f32 v215, v214, v203
    v_mul_f32 v216, v214, v201
    v_fmac_f32 v215, v213, v201
    buffer_load_dwordx4 v4, s[48:51], s83 offen offset:1024 lds
    v_fmac_f32 v216, v213, v202
    v_cvt_pk_bf16_f32 v125, v215, -v216
    v_mul_f32 v217, v198, v212
    v_mul_f32 v218, v198, v210
    buffer_load_dwordx4 v3, s[48:51], s84 offen offset:2048 lds
    v_fmac_f32 v217, v197, v210
    v_fmac_f32 v218, v197, v211
    v_cvt_pk_bf16_f32 v126, v217, -v218
    v_mul_f32 v213, v218, v206
    buffer_load_dwordx4 v4, s[48:51], s85 offen offset:3072 lds
    s_add_u32 m0, s70, 40960
    v_mul_f32 v214, v218, v204
    v_fmac_f32 v213, v217, v204
    v_fmac_f32 v214, v217, v205
    v_cvt_pk_bf16_f32 v127, v213, -v214
    buffer_load_dwordx4 v5, s[52:55], s86 offen offset:0 lds
    v_mul_f32 v219, v214, v206
    v_mul_f32 v220, v214, v204
    v_fmac_f32 v219, v213, v204
    v_fmac_f32 v220, v213, v205
    v_cvt_pk_bf16_f32 v128, v219, -v220
    buffer_load_dwordx4 v6, s[52:55], s87 offen offset:1024 lds
    s_add_u32 m0, s70, 49152
    v_mul_f32 v213, v220, v206
    v_mul_f32 v214, v220, v204
    v_fmac_f32 v213, v219, v204
    v_fmac_f32 v214, v219, v205
    buffer_load_dwordx4 v5, s[52:55], s88 offen offset:0 lds
    v_cvt_pk_bf16_f32 v129, v213, -v214
    v_mul_f32 v217, v214, v206
    v_mul_f32 v218, v214, v204
    v_fmac_f32 v217, v213, v204
    buffer_load_dwordx4 v6, s[52:55], s89 offen offset:1024 lds
    s_add_u32 m0, s70, 57344
    v_fmac_f32 v218, v213, v205
    v_cvt_pk_bf16_f32 v130, v217, -v218
    v_mul_f32 v213, v220, v212
    v_mul_f32 v214, v220, v210
    buffer_load_dwordx4 v5, s[52:55], s90 offen offset:0 lds
    v_fmac_f32 v213, v219, v210
    v_fmac_f32 v214, v219, v211
    v_cvt_pk_bf16_f32 v131, v213, -v214
    v_mul_f32 v215, v214, v212
    buffer_load_dwordx4 v6, s[52:55], s91 offen offset:1024 lds
    s_add_u32 s48, s48, 128
    s_addc_u32 s49, s49, 0
    s_add_u32 s52, s52, 393216
    s_addc_u32 s53, s53, 0
    v_mul_f32 v216, v214, v210
    v_fmac_f32 v215, v213, v210
    v_fmac_f32 v216, v213, v211
    v_cvt_pk_bf16_f32 v133, v215, -v216
    v_mul_f32 v213, v218, v212
    s_waitcnt vmcnt(20)
    s_waitcnt vmcnt(10)
    s_barrier
    s_add_u32 m0, s69, 81920
    s_nop 0
    buffer_load_dwordx4 v3, s[48:51], s82 offen offset:0 lds
    v_mul_f32 v214, v218, v210
    v_fmac_f32 v213, v217, v210
    v_fmac_f32 v214, v217, v211
    buffer_load_dwordx4 v4, s[48:51], s83 offen offset:1024 lds
    v_cvt_pk_bf16_f32 v132, v213, -v214
    v_mul_f32 v215, v214, v212
    v_mul_f32 v216, v214, v210
    v_fmac_f32 v215, v213, v210
    buffer_load_dwordx4 v3, s[48:51], s84 offen offset:2048 lds
    v_fmac_f32 v216, v213, v211
    v_cvt_pk_bf16_f32 v134, v215, -v216
    v_mul_f32 v213, v216, v212
    v_mul_f32 v214, v216, v210
    buffer_load_dwordx4 v4, s[48:51], s85 offen offset:3072 lds
    s_add_u32 m0, s70, 81920
    v_fmac_f32 v213, v215, v210
    v_fmac_f32 v214, v215, v211
    v_cvt_pk_bf16_f32 v135, v213, -v214
    v_mul_f32 v215, v214, v212
    buffer_load_dwordx4 v5, s[52:55], s86 offen offset:0 lds
    v_mul_f32 v216, v214, v210
    v_fmac_f32 v215, v213, v210
    v_fmac_f32 v216, v213, v211
    v_cvt_pk_bf16_f32 v136, v215, -v216
    buffer_load_dwordx4 v6, s[52:55], s87 offen offset:1024 lds
    s_add_u32 m0, s70, 90112
    v_mul_f32 v213, v216, v212
    v_mul_f32 v214, v216, v210
    v_fmac_f32 v213, v215, v210
    v_fmac_f32 v214, v215, v211
    buffer_load_dwordx4 v5, s[52:55], s88 offen offset:0 lds
    v_cvt_pk_bf16_f32 v137, v213, -v214
    v_mul_f32 v215, v214, v212
    v_mul_f32 v216, v214, v210
    v_fmac_f32 v215, v213, v210
    buffer_load_dwordx4 v6, s[52:55], s89 offen offset:1024 lds
    s_add_u32 m0, s70, 98304
    v_fmac_f32 v216, v213, v211
    v_cvt_pk_bf16_f32 v138, v215, -v216
    v_and_b32 v195, 0xffff0000, v12
    v_mul_f32 v195, 1069066811, v195
    buffer_load_dwordx4 v5, s[52:55], s90 offen offset:0 lds
    v_exp_f32 v195, v195
    v_and_b32 v196, 0xffff0000, v13
    v_and_b32 v197, 0xffff0000, v14
    v_cvt_pk_bf16_f32 v195, v195, v195
    buffer_load_dwordx4 v6, s[52:55], s91 offen offset:1024 lds
    s_add_u32 s48, s48, 128
    s_addc_u32 s49, s49, 0
    s_add_u32 s52, s52, 393216
    s_addc_u32 s53, s53, 0
    v_and_b32 v198, 0xffff0000, v15
    v_lshlrev_b32 v195, 16, v195
    v_mul_f32 v195, v195, v194
    v_mul_f32 v196, v196, v194
    s_add_u32 s74, s78, 12
    s_and_b32 s74, s74, 15
    s_lshl_b32 s75, s74, 7
    s_add_u32 s75, s75, 384
    s_bitcmp1_b32 s74, 2
    s_cselect_b32 s75, 0x7ff00000, s75
    s_mul_i32 s74, s74, 393216
    s_cmp_eq_u32 s68, 3
    s_cselect_b32 s75, 0, s75
    s_bitcmp0_b32 s68, 0
    s_cselect_b32 s75, s74, s75
    s_mov_b32 s74, 15
    s_bitcmp1_b32 s74, s68
    s_cselect_b32 s75, s75, 0x7ff00000
    buffer_load_dword v8, v7, s[56:59], s75 offen
    v_mul_f32 v197, v197, v194
    v_mul_f32 v198, v198, v194
    v_mul_f32 v195, 3216550459, v195
    v_mul_f32 v196, 1042479491, v196
    s_cmp_eq_u32 s68, 0
    s_cselect_b32 s66, 256, 0
    s_cselect_b32 s77, 64, 0
    s_mov_b64 s[64:65], s[28:29]
    s_mov_b32 s67, 0x20000
    s_and_b32 s74, s2, 3
    s_lshl_b32 s74, s74, 6
    s_mov_b64 exec, 1
    buffer_atomic_add v27, v19, s[64:67], s74 offen sc1
    s_mov_b64 exec, -1
    s_waitcnt vmcnt(12)
    s_barrier
    s_add_u32 m0, s69, 122880
    s_nop 0
    buffer_load_dwordx4 v3, s[48:51], s82 offen offset:0 lds
    v_add_f32 v197, v197, v197
    v_add_f32 v198, v198, v198
    v_mul_f32 v199, 1090519040, v195
    v_mul_f32 v200, 1090519040, v196
    buffer_load_dwordx4 v4, s[48:51], s83 offen offset:1024 lds
    v_exp_f32 v199, v199
    v_fract_f32 v200, v200
    v_cos_f32 v207, v200
    v_sin_f32 v208, v200
    buffer_load_dwordx4 v3, s[48:51], s84 offen offset:2048 lds
    v_mul_f32 v207, v199, v207
    v_mul_f32 v208, v199, v208
    v_sub_f32 v209, 0, v208
    v_mul_f32 v199, 1065353216, v195
    buffer_load_dwordx4 v4, s[48:51], s85 offen offset:3072 lds
    s_add_u32 m0, s70, 122880
    v_mul_f32 v200, 1065353216, v196
    v_exp_f32 v199, v199
    v_fract_f32 v200, v200
    v_cos_f32 v201, v200
    v_sin_f32 v202, v200
    buffer_load_dwordx4 v5, s[52:55], s86 offen offset:0 lds
    v_mul_f32 v201, v199, v201
    v_mul_f32 v202, v199, v202
    v_sub_f32 v203, 0, v202
    v_mul_f32 v199, 1132462080, v195
    buffer_load_dwordx4 v6, s[52:55], s87 offen offset:1024 lds
    s_add_u32 m0, s70, 131072
    v_mul_f32 v200, 1132462080, v196
    v_exp_f32 v199, v199
    v_fract_f32 v200, v200
    v_cos_f32 v210, v200
    buffer_load_dwordx4 v5, s[52:55], s88 offen offset:0 lds
    v_sin_f32 v211, v200
    v_mul_f32 v210, v199, v210
    v_mul_f32 v211, v199, v211
    v_sub_f32 v212, 0, v211
    v_mul_f32 v204, v202, v203
    buffer_load_dwordx4 v6, s[52:55], s89 offen offset:1024 lds
    s_add_u32 m0, s70, 139264
    v_mul_f32 v205, v202, v201
    v_fmac_f32 v204, v201, v201
    v_fmac_f32 v205, v201, v202
    v_sub_f32 v206, 0, v205
    buffer_load_dwordx4 v5, s[52:55], s90 offen offset:0 lds
    v_cvt_pk_bf16_f32 v86, v207, v208
    v_mul_f32 v213, v208, v209
    v_mul_f32 v214, v208, v207
    v_fmac_f32 v213, v207, v207
    buffer_load_dwordx4 v6, s[52:55], s91 offen offset:1024 lds
    s_add_u32 s48, s48, 128
    s_addc_u32 s49, s49, 0
    s_add_u32 s52, s52, 393216
    s_addc_u32 s53, s53, 0
    s_cmp_eq_u32 s78, 4
    s_cselect_b64 s[48:49], s[4:5], s[48:49]
    s_cselect_b64 s[52:53], s[20:21], s[52:53]
    v_fmac_f32 v214, v207, v208
    v_cvt_pk_bf16_f32 v87, v213, v214
    v_mul_f32 v215, v214, v209
    v_mul_f32 v216, v214, v207
    v_fmac_f32 v215, v213, v207
    s_waitcnt vmcnt(12)
    s_barrier
    s_add_u32 m0, s69, 40960
    s_nop 0
    buffer_load_dwordx4 v3, s[48:51], s82 offen offset:0 lds
    v_fmac_f32 v216, v213, v208
    v_cvt_pk_bf16_f32 v88, v215, v216
    v_mul_f32 v213, v216, v209
    v_mul_f32 v214, v216, v207
    buffer_load_dwordx4 v4, s[48:51], s83 offen offset:1024 lds
    v_fmac_f32 v213, v215, v207
    v_fmac_f32 v214, v215, v208
    v_cvt_pk_bf16_f32 v89, v213, v214
    v_mul_f32 v215, v214, v209
    buffer_load_dwordx4 v3, s[48:51], s84 offen offset:2048 lds
    v_mul_f32 v216, v214, v207
    v_fmac_f32 v215, v213, v207
    v_fmac_f32 v216, v213, v208
    v_cvt_pk_bf16_f32 v90, v215, v216
    buffer_load_dwordx4 v4, s[48:51], s85 offen offset:3072 lds
    s_add_u32 m0, s70, 40960
    v_mul_f32 v213, v216, v209
    v_mul_f32 v214, v216, v207
    v_fmac_f32 v213, v215, v207
    v_fmac_f32 v214, v215, v208
    v_cvt_pk_bf16_f32 v91, v213, v214
    buffer_load_dwordx4 v5, s[52:55], s86 offen offset:0 lds
    v_mul_f32 v215, v214, v209
    v_mul_f32 v216, v214, v207
    v_fmac_f32 v215, v213, v207
    v_fmac_f32 v216, v213, v208
    buffer_load_dwordx4 v6, s[52:55], s87 offen offset:1024 lds
    s_add_u32 m0, s70, 49152
    v_cvt_pk_bf16_f32 v92, v215, v216
    v_mul_f32 v213, v216, v209
    v_mul_f32 v214, v216, v207
    v_fmac_f32 v213, v215, v207
    buffer_load_dwordx4 v5, s[52:55], s88 offen offset:0 lds
    v_fmac_f32 v214, v215, v208
    v_cvt_pk_bf16_f32 v93, v213, v214
    v_mul_f32 v215, v214, v209
    v_mul_f32 v216, v214, v207
    v_fmac_f32 v215, v213, v207
    buffer_load_dwordx4 v6, s[52:55], s89 offen offset:1024 lds
    s_add_u32 m0, s70, 57344
    v_fmac_f32 v216, v213, v208
    v_cvt_pk_bf16_f32 v94, v215, v216
    v_mul_f32 v213, v216, v209
    v_mul_f32 v214, v216, v207
    buffer_load_dwordx4 v5, s[52:55], s90 offen offset:0 lds
    v_fmac_f32 v213, v215, v207
    v_fmac_f32 v214, v215, v208
    v_cvt_pk_bf16_f32 v95, v213, v214
    v_mul_f32 v215, v214, v209
    buffer_load_dwordx4 v6, s[52:55], s91 offen offset:1024 lds
    s_add_u32 s48, s48, 128
    s_addc_u32 s49, s49, 0
    s_add_u32 s52, s52, 393216
    s_addc_u32 s53, s53, 0
    v_mul_f32 v216, v214, v207
    v_fmac_f32 v215, v213, v207
    v_fmac_f32 v216, v213, v208
    v_cvt_pk_bf16_f32 v96, v215, v216
    v_mul_f32 v213, v216, v209
    s_waitcnt vmcnt(10)
    s_barrier
    s_add_u32 m0, s69, 81920
    s_nop 0
    buffer_load_dwordx4 v3, s[48:51], s82 offen offset:0 lds
    v_mul_f32 v214, v216, v207
    v_fmac_f32 v213, v215, v207
    v_fmac_f32 v214, v215, v208
    buffer_load_dwordx4 v4, s[48:51], s83 offen offset:1024 lds
    v_cvt_pk_bf16_f32 v97, v213, v214
    v_mul_f32 v215, v214, v209
    v_mul_f32 v216, v214, v207
    buffer_load_dwordx4 v3, s[48:51], s84 offen offset:2048 lds
    v_fmac_f32 v215, v213, v207
    v_fmac_f32 v216, v213, v208
    v_cvt_pk_bf16_f32 v98, v215, v216
    buffer_load_dwordx4 v4, s[48:51], s85 offen offset:3072 lds
    s_add_u32 m0, s70, 81920
    v_mul_f32 v213, v216, v209
    v_mul_f32 v214, v216, v207
    v_fmac_f32 v213, v215, v207
    buffer_load_dwordx4 v5, s[52:55], s86 offen offset:0 lds
    v_fmac_f32 v214, v215, v208
    v_cvt_pk_bf16_f32 v99, v213, v214
    v_mul_f32 v215, v214, v209
    buffer_load_dwordx4 v6, s[52:55], s87 offen offset:1024 lds
    s_add_u32 m0, s70, 90112
    v_mul_f32 v216, v214, v207
    v_fmac_f32 v215, v213, v207
    v_fmac_f32 v216, v213, v208
    buffer_load_dwordx4 v5, s[52:55], s88 offen offset:0 lds
    v_cvt_pk_bf16_f32 v100, v215, v216
    v_mul_f32 v213, v216, v209
    v_mul_f32 v214, v216, v207
    buffer_load_dwordx4 v6, s[52:55], s89 offen offset:1024 lds
    s_add_u32 m0, s70, 98304
    v_fmac_f32 v213, v215, v207
    v_fmac_f32 v214, v215, v208
    v_cvt_pk_bf16_f32 v101, v213, v214
    buffer_load_dwordx4 v5, s[52:55], s90 offen offset:0 lds
    v_mul_f32 v215, v214, v209
    v_mul_f32 v216, v214, v207
    v_fmac_f32 v215, v213, v207
    buffer_load_dwordx4 v6, s[52:55], s91 offen offset:1024 lds
    s_add_u32 s48, s48, 128
    s_addc_u32 s49, s49, 0
    s_add_u32 s52, s52, 393216
    s_addc_u32 s53, s53, 0
    v_fmac_f32 v216, v213, v208
    v_cvt_pk_bf16_f32 v102, v215, v216
    v_mul_f32 v213, v216, v209
    s_mov_b32 m0, s73
    s_mov_b32 s74, 0x7ff00000
    s_mov_b64 exec, 0xffffffff
    buffer_load_dwordx4 v22, s[32:35], s74 offen lds
    s_mov_b64 exec, -1
    v_mul_f32 v214, v216, v207
    v_fmac_f32 v213, v215, v207
    v_fmac_f32 v214, v215, v208
    v_cvt_pk_bf16_f32 v103, v213, v214
    s_waitcnt vmcnt(11)
    s_barrier
    s_add_u32 m0, s69, 122880
    s_nop 0
    buffer_load_dwordx4 v3, s[48:51], s82 offen offset:0 lds
    v_mul_f32 v215, v214, v209
    v_mul_f32 v216, v214, v207
    v_fmac_f32 v215, v213, v207
    v_fmac_f32 v216, v213, v208
    buffer_load_dwordx4 v4, s[48:51], s83 offen offset:1024 lds
    v_cvt_pk_bf16_f32 v104, v215, v216
    v_mul_f32 v213, v216, v209
    v_mul_f32 v214, v216, v207
    v_fmac_f32 v213, v215, v207
    buffer_load_dwordx4 v3, s[48:51], s84 offen offset:2048 lds
    v_fmac_f32 v214, v215, v208
    v_cvt_pk_bf16_f32 v105, v213, v214
    v_mul_f32 v215, v214, v209
    v_mul_f32 v216, v214, v207
    buffer_load_dwordx4 v4, s[48:51], s85 offen offset:3072 lds
    s_add_u32 m0, s70, 122880
    v_fmac_f32 v215, v213, v207
    v_fmac_f32 v216, v213, v208
    v_cvt_pk_bf16_f32 v106, v215, v216
    v_mul_f32 v213, v216, v209
    v_mul_f32 v214, v216, v207
    buffer_load_dwordx4 v5, s[52:55], s86 offen offset:0 lds
    v_fmac_f32 v213, v215, v207
    v_fmac_f32 v214, v215, v208
    v_cvt_pk_bf16_f32 v107, v213, v214
    v_mul_f32 v215, v214, v209
    buffer_load_dwordx4 v6, s[52:55], s87 offen offset:1024 lds
    s_add_u32 m0, s70, 131072
    v_mul_f32 v216, v214, v207
    v_fmac_f32 v215, v213, v207
    v_fmac_f32 v216, v213, v208
    v_cvt_pk_bf16_f32 v108, v215, v216
    buffer_load_dwordx4 v5, s[52:55], s88 offen offset:0 lds
    v_mul_f32 v213, v216, v209
    v_mul_f32 v214, v216, v207
    v_fmac_f32 v213, v215, v207
    v_fmac_f32 v214, v215, v208
    v_cvt_pk_bf16_f32 v109, v213, v214
    buffer_load_dwordx4 v6, s[52:55], s89 offen offset:1024 lds
    s_add_u32 m0, s70, 139264
    v_mul_f32 v215, v214, v209
    v_mul_f32 v216, v214, v207
    v_fmac_f32 v215, v213, v207
    v_fmac_f32 v216, v213, v208
    buffer_load_dwordx4 v5, s[52:55], s90 offen offset:0 lds
    v_cvt_pk_bf16_f32 v110, v215, v216
    v_mul_f32 v213, v216, v209
    v_mul_f32 v214, v216, v207
    v_fmac_f32 v213, v215, v207
    buffer_load_dwordx4 v6, s[52:55], s91 offen offset:1024 lds
    s_add_u32 s48, s48, 128
    s_addc_u32 s49, s49, 0
    s_add_u32 s52, s52, 393216
    s_addc_u32 s53, s53, 0
    v_fmac_f32 v214, v215, v208
    v_cvt_pk_bf16_f32 v111, v213, v214
    v_mul_f32 v215, v214, v209
    v_mul_f32 v216, v214, v207
    v_fmac_f32 v215, v213, v207
    s_waitcnt vmcnt(11)
    s_barrier
    buffer_load_dword v20, v21, s[64:67], 0 offen sc1
    s_add_u32 m0, s69, 40960
    s_nop 0
    buffer_load_dwordx4 v3, s[48:51], s82 offen offset:0 lds
    v_fmac_f32 v216, v213, v208
    v_cvt_pk_bf16_f32 v112, v215, v216
    v_mul_f32 v213, v216, v209
    v_mul_f32 v214, v216, v207
    buffer_load_dwordx4 v4, s[48:51], s83 offen offset:1024 lds
    v_fmac_f32 v213, v215, v207
    v_fmac_f32 v214, v215, v208
    v_cvt_pk_bf16_f32 v113, v213, v214
    v_mul_f32 v215, v214, v209
    buffer_load_dwordx4 v3, s[48:51], s84 offen offset:2048 lds
    v_mul_f32 v216, v214, v207
    v_fmac_f32 v215, v213, v207
    v_fmac_f32 v216, v213, v208
    v_cvt_pk_bf16_f32 v114, v215, v216
    buffer_load_dwordx4 v4, s[48:51], s85 offen offset:3072 lds
    s_add_u32 m0, s70, 40960
    v_mul_f32 v213, v216, v209
    v_mul_f32 v214, v216, v207
    v_fmac_f32 v213, v215, v207
    v_fmac_f32 v214, v215, v208
    buffer_load_dwordx4 v5, s[52:55], s86 offen offset:0 lds
    v_cvt_pk_bf16_f32 v115, v213, v214
    v_mul_f32 v215, v214, v209
    v_mul_f32 v216, v214, v207
    v_fmac_f32 v215, v213, v207
    v_fmac_f32 v216, v213, v208
    buffer_load_dwordx4 v6, s[52:55], s87 offen offset:1024 lds
    s_add_u32 m0, s70, 49152
    v_cvt_pk_bf16_f32 v116, v215, v216
    v_cvt_pk_bf16_f32 v139, v197, -v198
    v_mul_f32 v213, v198, v203
    v_mul_f32 v214, v198, v201
    buffer_load_dwordx4 v5, s[52:55], s88 offen offset:0 lds
    v_fmac_f32 v213, v197, v201
    v_fmac_f32 v214, v197, v202
    v_cvt_pk_bf16_f32 v140, v213, -v214
    v_mul_f32 v215, v214, v203
    buffer_load_dwordx4 v6, s[52:55], s89 offen offset:1024 lds
    s_add_u32 m0, s70, 57344
    v_mul_f32 v216, v214, v201
    v_fmac_f32 v215, v213, v201
    v_fmac_f32 v216, v213, v202
    v_cvt_pk_bf16_f32 v141, v215, -v216
    buffer_load_dwordx4 v5, s[52:55], s90 offen offset:0 lds
    v_mul_f32 v213, v216, v203
    v_mul_f32 v214, v216, v201
    v_fmac_f32 v213, v215, v201
    v_fmac_f32 v214, v215, v202
    buffer_load_dwordx4 v6, s[52:55], s91 offen offset:1024 lds
    s_add_u32 s48, s48, 128
    s_addc_u32 s49, s49, 0
    s_add_u32 s52, s52, 393216
    s_addc_u32 s53, s53, 0
    v_cvt_pk_bf16_f32 v142, v213, -v214
    v_mul_f32 v215, v214, v203
    v_mul_f32 v216, v214, v201
    v_fmac_f32 v215, v213, v201
    v_fmac_f32 v216, v213, v202
    s_waitcnt vmcnt(10)
    v_cmp_gt_u32 vcc, s77, v20
    s_cbranch_vccnz L_eslow
L_eback:
    s_barrier
    s_mov_b32 s56, s22
    s_mov_b32 s57, s23
    s_mov_b32 s58, 2097152
    s_mov_b32 s59, 0x20000
    s_lshl_b32 s69, s68, 11
    s_add_u32 m0, s73, 512
    s_mov_b32 s74, 0
    buffer_load_dwordx4 v22, s[32:35], s74 offen offset:0 sc1 lds
    v_cvt_pk_bf16_f32 v143, v215, -v216
    v_mul_f32 v213, v216, v203
    v_mul_f32 v214, v216, v201
    v_fmac_f32 v213, v215, v201
    v_fmac_f32 v214, v215, v202
    s_mov_b32 s74, 3072
    buffer_load_dwordx4 v22, s[32:35], s74 offen offset:1024 sc1 lds
    v_cvt_pk_bf16_f32 v144, v213, -v214
    v_mul_f32 v215, v214, v203
    v_mul_f32 v216, v214, v201
    v_fmac_f32 v215, v213, v201
    v_fmac_f32 v216, v213, v202
    s_mov_b32 s74, 6144
    buffer_load_dwordx4 v22, s[32:35], s74 offen offset:2048 sc1 lds
    v_cvt_pk_bf16_f32 v145, v215, -v216
    v_mul_f32 v213, v216, v203
    v_mul_f32 v214, v216, v201
    v_fmac_f32 v213, v215, v201
    v_fmac_f32 v214, v215, v202
    v_cvt_pk_bf16_f32 v146, v213, -v214
    s_mov_b32 s74, 9216
    buffer_load_dwordx4 v22, s[32:35], s74 offen offset:3072 sc1 lds
    v_mul_f32 v215, v214, v203
    v_mul_f32 v216, v214, v201
    v_fmac_f32 v215, v213, v201
    v_fmac_f32 v216, v213, v202
    v_cvt_pk_bf16_f32 v147, v215, -v216
    s_add_u32 m0, s69, 81920
    s_add_u32 s74, s44, 0
    s_and_b32 s74, s74, 15
    s_lshl_b32 s74, s74, 17
    buffer_load_dwordx4 v23, s[56:59], s74 offen lds
    v_mul_f32 v217, v198, v212
    v_mul_f32 v218, v198, v210
    v_fmac_f32 v217, v197, v210
    v_fmac_f32 v218, v197, v211
    v_cvt_pk_bf16_f32 v148, v217, -v218
    s_add_u32 s74, s74, 15360
    buffer_load_dwordx4 v23, s[56:59], s74 offen offset:1024 lds
    v_mul_f32 v213, v218, v206
    v_mul_f32 v214, v218, v204
    v_fmac_f32 v213, v217, v204
    v_fmac_f32 v214, v217, v205
    v_cvt_pk_bf16_f32 v149, v213, -v214
    v_mul_f32 v219, v214, v206
    s_add_u32 m0, s69, 90112
    s_add_u32 s74, s44, 1
    s_and_b32 s74, s74, 15
    s_lshl_b32 s74, s74, 17
    buffer_load_dwordx4 v23, s[56:59], s74 offen lds
    v_mul_f32 v220, v214, v204
    v_fmac_f32 v219, v213, v204
    v_fmac_f32 v220, v213, v205
    v_cvt_pk_bf16_f32 v150, v219, -v220
    v_mul_f32 v213, v220, v206
    s_add_u32 s74, s74, 15360
    buffer_load_dwordx4 v23, s[56:59], s74 offen offset:1024 lds
    v_mul_f32 v214, v220, v204
    v_fmac_f32 v213, v219, v204
    v_fmac_f32 v214, v219, v205
    v_cvt_pk_bf16_f32 v151, v213, -v214
    v_mul_f32 v217, v214, v206
    v_mul_f32 v218, v214, v204
    s_waitcnt vmcnt(8)
    s_barrier
    s_add_u32 m0, s69, 98304
    s_add_u32 s74, s44, 2
    s_and_b32 s74, s74, 15
    s_lshl_b32 s74, s74, 17
    buffer_load_dwordx4 v23, s[56:59], s74 offen lds
    v_fmac_f32 v217, v213, v204
    v_fmac_f32 v218, v213, v205
    s_add_u32 s74, s74, 15360
    buffer_load_dwordx4 v23, s[56:59], s74 offen offset:1024 lds
    v_cvt_pk_bf16_f32 v152, v217, -v218
    v_mul_f32 v213, v220, v212
    s_add_u32 m0, s69, 106496
    s_add_u32 s74, s44, 3
    s_and_b32 s74, s74, 15
    s_lshl_b32 s74, s74, 17
    buffer_load_dwordx4 v23, s[56:59], s74 offen lds
    v_mul_f32 v214, v220, v210
    v_fmac_f32 v213, v219, v210
    v_fmac_f32 v214, v219, v211
    s_add_u32 s74, s74, 15360
    buffer_load_dwordx4 v23, s[56:59], s74 offen offset:1024 lds
    v_cvt_pk_bf16_f32 v153, v213, -v214
    v_mul_f32 v215, v214, v212
    s_add_u32 m0, s69, 114688
    s_add_u32 s74, s44, 4
    s_and_b32 s74, s74, 15
    s_lshl_b32 s74, s74, 17
    buffer_load_dwordx4 v23, s[56:59], s74 offen lds
    v_mul_f32 v216, v214, v210
    v_fmac_f32 v215, v213, v210
    s_add_u32 s74, s74, 15360
    buffer_load_dwordx4 v23, s[56:59], s74 offen offset:1024 lds
    v_fmac_f32 v216, v213, v211
    v_cvt_pk_bf16_f32 v155, v215, -v216
    v_mul_f32 v213, v218, v212
    s_add_u32 m0, s69, 122880
    s_add_u32 s74, s44, 5
    s_and_b32 s74, s74, 15
    s_lshl_b32 s74, s74, 17
    buffer_load_dwordx4 v23, s[56:59], s74 offen lds
    v_mul_f32 v214, v218, v210
    v_fmac_f32 v213, v217, v210
    s_add_u32 s74, s74, 15360
    buffer_load_dwordx4 v23, s[56:59], s74 offen offset:1024 lds
    v_fmac_f32 v214, v217, v211
    v_cvt_pk_bf16_f32 v154, v213, -v214
    v_mul_f32 v215, v214, v212
    s_add_u32 m0, s69, 131072
    s_add_u32 s74, s44, 6
    s_and_b32 s74, s74, 15
    s_lshl_b32 s74, s74, 17
    buffer_load_dwordx4 v23, s[56:59], s74 offen lds
    v_mul_f32 v216, v214, v210
    v_fmac_f32 v215, v213, v210
    s_add_u32 s74, s74, 15360
    buffer_load_dwordx4 v23, s[56:59], s74 offen offset:1024 lds
    v_fmac_f32 v216, v213, v211
    v_cvt_pk_bf16_f32 v156, v215, -v216
    s_add_u32 m0, s69, 139264
    s_add_u32 s74, s44, 7
    s_and_b32 s74, s74, 15
    s_lshl_b32 s74, s74, 17
    buffer_load_dwordx4 v23, s[56:59], s74 offen lds
    v_mul_f32 v213, v216, v212
    v_mul_f32 v214, v216, v210
    v_fmac_f32 v213, v215, v210
    s_add_u32 s74, s74, 15360
    buffer_load_dwordx4 v23, s[56:59], s74 offen offset:1024 lds
    v_fmac_f32 v214, v215, v211
    v_cvt_pk_bf16_f32 v157, v213, -v214
    s_add_u32 m0, s69, 147456
    s_add_u32 s74, s44, 8
    s_and_b32 s74, s74, 15
    s_lshl_b32 s74, s74, 17
    buffer_load_dwordx4 v23, s[56:59], s74 offen lds
    v_mul_f32 v215, v214, v212
    v_mul_f32 v216, v214, v210
    v_fmac_f32 v215, v213, v210
    s_add_u32 s74, s74, 15360
    buffer_load_dwordx4 v23, s[56:59], s74 offen offset:1024 lds
    v_fmac_f32 v216, v213, v211
    v_cvt_pk_bf16_f32 v158, v215, -v216
    s_add_u32 m0, s69, 155648
    s_add_u32 s74, s44, 9
    s_and_b32 s74, s74, 15
    s_lshl_b32 s74, s74, 17
    buffer_load_dwordx4 v23, s[56:59], s74 offen lds
    v_mul_f32 v213, v216, v212
    v_mul_f32 v214, v216, v210
    s_add_u32 s74, s74, 15360
    buffer_load_dwordx4 v23, s[56:59], s74 offen offset:1024 lds
    v_fmac_f32 v213, v215, v210
    v_fmac_f32 v214, v215, v211
    v_cvt_pk_bf16_f32 v159, v213, -v214
    s_add_u32 m0, s69, 32768
    s_add_u32 s74, s44, 10
    s_and_b32 s74, s74, 15
    s_lshl_b32 s74, s74, 17
    buffer_load_dwordx4 v23, s[56:59], s74 offen lds
    v_mul_f32 v215, v214, v212
    v_mul_f32 v216, v214, v210
    s_add_u32 s74, s74, 15360
    buffer_load_dwordx4 v23, s[56:59], s74 offen offset:1024 lds
    v_fmac_f32 v215, v213, v210
    v_fmac_f32 v216, v213, v211
    v_cvt_pk_bf16_f32 v160, v215, -v216
    s_mov_b32 s43, 0
L_go_7:
    ds_read_b32 v20, v19 offset:4624
    s_add_u32 s43, s43, 1
    s_cmp_gt_u32 s43, 400000
    s_waitcnt lgkmcnt(0)
    s_cbranch_scc1 L_go_7_d
    v_cmp_gt_u32 vcc, 4, v20
    s_cbranch_vccz L_go_7_d
    s_sleep 1
    s_branch L_go_7
L_go_7_d:
    s_sub_u32 m0, s72, 16384
    v_mov_b32 v220, 0x3f80
    v_mov_b32 v214, 0
    v_mov_b32 v215, 0
    v_mov_b32 v216, 0
    v_mov_b32 v217, 0
    ds_write_addtid_b32 v220 offset:16384
    ds_write_addtid_b32 v55 offset:16656
    ds_write_addtid_b32 v56 offset:16928
    ds_write_addtid_b32 v57 offset:17200
    ds_write_addtid_b32 v58 offset:17472
    ds_write_addtid_b32 v59 offset:17744
    ds_write_addtid_b32 v60 offset:18016
    ds_write_addtid_b32 v61 offset:18288
    ds_write_addtid_b32 v62 offset:18560
    ds_write_addtid_b32 v63 offset:18832
    ds_write_addtid_b32 v64 offset:19104
    ds_write_addtid_b32 v65 offset:19376
    ds_write_addtid_b32 v66 offset:19648
    ds_write_addtid_b32 v67 offset:19920
    ds_write_addtid_b32 v68 offset:20192
    ds_write_addtid_b32 v69 offset:20464
    ds_write_addtid_b32 v70 offset:20736
    ds_write_addtid_b32 v71 offset:21008
    ds_write_addtid_b32 v72 offset:21280
    ds_write_addtid_b32 v73 offset:21552
    ds_write_addtid_b32 v74 offset:21824
    ds_write_addtid_b32 v75 offset:22096
    ds_write_addtid_b32 v76 offset:22368
    ds_write_addtid_b32 v77 offset:22640
    ds_write_addtid_b32 v78 offset:22912
    ds_write_addtid_b32 v79 offset:23184
    ds_write_addtid_b32 v80 offset:23456
    ds_write_addtid_b32 v81 offset:23728
    ds_write_addtid_b32 v82 offset:24000
    ds_write_addtid_b32 v83 offset:24272
    ds_write_addtid_b32 v84 offset:24544
    ds_write_addtid_b32 v85 offset:24816
    ds_read_b128 v[162:165], v28 offset:0
    ds_read_b128 v[166:169], v28 offset:32
    ds_read_b128 v[170:173], v28 offset:64
    ds_read_b128 v[174:177], v28 offset:96
    ds_read_b128 v[178:181], v28 offset:128
    ds_read_b128 v[182:185], v28 offset:160
    ds_read_b128 v[186:189], v28 offset:192
    ds_read_b128 v[190:193], v28 offset:224
    ds_write_addtid_b32 v117 offset:16384
    ds_write_addtid_b32 v118 offset:16656
    ds_write_addtid_b32 v119 offset:16928
    ds_write_addtid_b32 v120 offset:17200
    ds_write_addtid_b32 v121 offset:18560
    ds_write_addtid_b32 v122 offset:18832
    ds_write_addtid_b32 v123 offset:19104
    ds_write_addtid_b32 v124 offset:19376
    ds_write_addtid_b32 v125 offset:20736
    ds_write_addtid_b32 v126 offset:17472
    ds_write_addtid_b32 v126 offset:17744
    ds_write_addtid_b32 v127 offset:18016
    ds_write_addtid_b32 v128 offset:18288
    ds_write_addtid_b32 v128 offset:19648
    ds_write_addtid_b32 v128 offset:19920
    ds_write_addtid_b32 v129 offset:20192
    ds_write_addtid_b32 v130 offset:20464
    ds_write_addtid_b32 v130 offset:21824
    ds_write_addtid_b32 v131 offset:21008
    ds_write_addtid_b32 v132 offset:21280
    ds_write_addtid_b32 v133 offset:22096
    ds_write_addtid_b32 v134 offset:22368
    ds_write_addtid_b32 v135 offset:21552
    ds_write_addtid_b32 v136 offset:22640
    ds_write_addtid_b32 v137 offset:22912
    ds_write_addtid_b32 v138 offset:24000
    ds_read_b128 v[54:57], v28 offset:0
    ds_read_b128 v[58:61], v28 offset:32
    ds_read_b128 v[62:65], v28 offset:64
    ds_read_b128 v[66:69], v28 offset:96
    ds_read_b128 v[70:73], v28 offset:128
    ds_read_b128 v[74:77], v28 offset:160
    ds_read_b128 v[78:81], v28 offset:192
    ds_read_b128 v[82:85], v28 offset:224
    ds_write_addtid_b32 v220 offset:16384
    ds_write_addtid_b32 v86 offset:16656
    ds_write_addtid_b32 v87 offset:16928
    ds_write_addtid_b32 v88 offset:17200
    ds_write_addtid_b32 v89 offset:17472
    ds_write_addtid_b32 v90 offset:17744
    ds_write_addtid_b32 v91 offset:18016
    ds_write_addtid_b32 v92 offset:18288
    s_waitcnt lgkmcnt(14)
    v_mfma_f32_32x32x16_bf16 v[194:209], v[54:57], v[162:165], 0
    ds_write_addtid_b32 v93 offset:18560
    ds_write_addtid_b32 v94 offset:18832
    ds_write_addtid_b32 v95 offset:19104
    v_mfma_f32_32x32x16_bf16 v[194:209], v[58:61], v[166:169], v[194:209]
    ds_write_addtid_b32 v96 offset:19376
    ds_write_addtid_b32 v97 offset:19648
    ds_write_addtid_b32 v98 offset:19920
    s_waitcnt lgkmcnt(14)
    v_mfma_f32_32x32x16_bf16 v[194:209], v[62:65], v[170:173], v[194:209]
    ds_write_addtid_b32 v99 offset:20192
    ds_write_addtid_b32 v100 offset:20464
    ds_write_addtid_b32 v101 offset:20736
    v_mfma_f32_32x32x16_bf16 v[194:209], v[66:69], v[174:177], v[194:209]
    ds_write_addtid_b32 v102 offset:21008
    ds_write_addtid_b32 v103 offset:21280
    ds_write_addtid_b32 v104 offset:21552
    v_mfma_f32_32x32x16_bf16 v[194:209], v[70:73], v[178:181], v[194:209]
    ds_write_addtid_b32 v105 offset:21824
    ds_write_addtid_b32 v106 offset:22096
    ds_write_addtid_b32 v107 offset:22368
    v_mfma_f32_32x32x16_bf16 v[194:209], v[74:77], v[182:185], v[194:209]
    ds_write_addtid_b32 v108 offset:22640
    ds_write_addtid_b32 v109 offset:22912
    ds_write_addtid_b32 v110 offset:23184
    v_mfma_f32_32x32x16_bf16 v[194:209], v[78:81], v[186:189], v[194:209]
    ds_write_addtid_b32 v111 offset:23456
    ds_write_addtid_b32 v112 offset:23728
    ds_write_addtid_b32 v113 offset:24000
    v_mfma_f32_32x32x16_bf16 v[194:209], v[82:85], v[190:193], v[194:209]
    ds_write_addtid_b32 v114 offset:24272
    ds_write_addtid_b32 v115 offset:24544
    ds_write_addtid_b32 v116 offset:24816
    ds_read_b128 v[86:89], v28 offset:0
    ds_read_b128 v[90:93], v28 offset:32
    ds_read_b128 v[94:97], v28 offset:64
    ds_read_b128 v[98:101], v28 offset:96
    ds_read_b128 v[102:105], v28 offset:128
    ds_read_b128 v[106:109], v28 offset:160
    ds_read_b128 v[110:113], v28 offset:192
    ds_read_b128 v[114:117], v28 offset:224
    ds_write_addtid_b32 v139 offset:16384
    ds_write_addtid_b32 v140 offset:16656
    ds_write_addtid_b32 v141 offset:16928
    ds_write_addtid_b32 v142 offset:17200
    ds_write_addtid_b32 v143 offset:18560
    ds_write_addtid_b32 v144 offset:18832
    ds_write_addtid_b32 v145 offset:19104
    ds_write_addtid_b32 v146 offset:19376
    ds_write_addtid_b32 v147 offset:20736
    ds_write_addtid_b32 v148 offset:17472
    ds_write_addtid_b32 v148 offset:17744
    ds_write_addtid_b32 v149 offset:18016
    ds_write_addtid_b32 v150 offset:18288
    ds_write_addtid_b32 v150 offset:19648
    ds_write_addtid_b32 v150 offset:19920
    ds_write_addtid_b32 v151 offset:20192
    ds_write_addtid_b32 v152 offset:20464
    ds_write_addtid_b32 v152 offset:21824
    ds_write_addtid_b32 v153 offset:21008
    ds_write_addtid_b32 v154 offset:21280
    ds_write_addtid_b32 v155 offset:22096
    ds_write_addtid_b32 v156 offset:22368
    ds_write_addtid_b32 v157 offset:21552
    ds_write_addtid_b32 v158 offset:22640
    ds_write_addtid_b32 v159 offset:22912
    ds_write_addtid_b32 v160 offset:24000
    ds_read_b128 v[54:57], v28 offset:0
    ds_read_b128 v[58:61], v28 offset:32
    ds_read_b128 v[62:65], v28 offset:64
    ds_read_b128 v[66:69], v28 offset:96
    ds_read_b128 v[70:73], v28 offset:128
    ds_read_b128 v[74:77], v28 offset:160
    ds_read_b128 v[78:81], v28 offset:192
    ds_read_b128 v[82:85], v28 offset:224
    v_lshl_add_u32 v218, v0, 4, s72
    s_waitcnt lgkmcnt(7)
    v_mfma_f32_32x32x16_bf16 v[194:209], v[54:57], v[86:89], v[194:209]
    s_waitcnt lgkmcnt(6)
    v_mfma_f32_32x32x16_bf16 v[194:209], v[58:61], v[90:93], v[194:209]
    ds_write_b128 v218, v[214:217] offset:0
    s_waitcnt lgkmcnt(6)
    v_mfma_f32_32x32x16_bf16 v[194:209], v[62:65], v[94:97], v[194:209]
    s_waitcnt lgkmcnt(5)
    v_mfma_f32_32x32x16_bf16 v[194:209], v[66:69], v[98:101], v[194:209]
    ds_write_b128 v218, v[214:217] offset:1024
    s_waitcnt lgkmcnt(5)
    v_mfma_f32_32x32x16_bf16 v[194:209], v[70:73], v[102:105], v[194:209]
    s_waitcnt lgkmcnt(4)
    v_mfma_f32_32x32x16_bf16 v[194:209], v[74:77], v[106:109], v[194:209]
    ds_write_b128 v218, v[214:217] offset:2048
    s_waitcnt lgkmcnt(4)
    v_mfma_f32_32x32x16_bf16 v[194:209], v[78:81], v[110:113], v[194:209]
    s_waitcnt lgkmcnt(3)
    v_mfma_f32_32x32x16_bf16 v[194:209], v[82:85], v[114:117], v[194:209]
    ds_write_b128 v218, v[214:217] offset:3072
    v_cmp_eq_u32 vcc, 0, v0
    s_nop 1
    v_cndmask_b32 v218, 0, v10, vcc
    v_lshl_add_u32 v219, v0, 1, s72
    s_nop 5
    v_add_f32 v194, v194, v218
    v_cvt_pk_bf16_f32 v210, v201, v200
    v_cvt_pk_bf16_f32 v211, v199, v198
    v_cvt_pk_bf16_f32 v212, v197, v196
    v_cvt_pk_bf16_f32 v213, v195, v194
    ds_write_b128 v29, v[210:213]
    v_cvt_pk_bf16_f32 v214, v202, v201
    v_cvt_pk_bf16_f32 v215, v200, v199
    v_cvt_pk_bf16_f32 v216, v198, v197
    v_cvt_pk_bf16_f32 v217, v196, v195
    ds_write_b128 v29, v[214:217] offset:1216
    v_cvt_pk_bf16_f32 v210, v19, v202
    v_cvt_pk_bf16_f32 v211, v202, v202
    v_cvt_pk_bf16_f32 v212, v194, v19
    v_cvt_pk_bf16_f32 v213, v203, v204
    v_cvt_pk_bf16_f32 v214, v205, v206
    v_cvt_pk_bf16_f32 v215, v204, v204
    v_mov_b32 v218, s72
    ds_write_addtid_b32 v213 offset:18880
    ds_write_b16 v219, v214 offset:2944
    ds_write_b16_d16_hi v219, v214 offset:3072
    s_mov_b64 exec, 1
    ds_write_b32 v218, v212 offset:2304
    s_mov_b32 s46, 0
    s_mov_b32 s47, 0x80000000
    s_mov_b64 exec, s[46:47]
    ds_write_b64 v218, v[210:211] offset:56
    ds_write_b32 v218, v211 offset:1276
    s_mov_b64 exec, -1
    v_readlane_b32 s81, v215, 63
    s_nop 1
    v_and_b32 v50, s81, v50
    v_and_b32 v51, s81, v51
    v_and_b32 v52, s81, v52
    v_and_b32 v53, s81, v53
    s_waitcnt vmcnt(22)
    ds_read_b128 v[230:233], v25 offset:448
    ds_read_b128 v[234:237], v25 offset:432
    ds_read2_b32 v[54:55], v31 offset0:128 offset1:129
    ds_read2_b32 v[56:57], v31 offset0:130 offset1:131
    ds_read2_b32 v[86:87], v31 offset0:0 offset1:1
    ds_read2_b32 v[88:89], v31 offset0:2 offset1:3
    ds_read2_b32 v[118:119], v30 offset0:0 offset1:1
    ds_read2_b32 v[120:121], v30 offset0:2 offset1:3
    ds_read_b128 v[238:241], v25 offset:384
    ds_read_b128 v[242:245], v25 offset:896
    ds_read_b128 v[246:249], v25 offset:1408
    ds_read_b128 v[250:253], v25 offset:1920
    s_add_u32 s70, s44, 11
    s_lshl_b32 s70, s70, 17
    s_mul_i32 s40, s68, 163840
    s_add_u32 s70, s70, s40
    s_waitcnt lgkmcnt(8)
    v_mfma_f32_16x16x32_bf16 v[162:165], v[54:57], v[230:233], 0
    ds_read2_b32 v[58:59], v31 offset0:112 offset1:113
    ds_read2_b32 v[60:61], v31 offset0:114 offset1:115
    s_waitcnt lgkmcnt(8)
    v_mfma_f32_16x16x32_bf16 v[166:169], v[86:89], v[230:233], 0
    ds_read2_b32 v[90:91], v30 offset0:112 offset1:113
    ds_read2_b32 v[92:93], v30 offset0:114 offset1:115
    s_waitcnt lgkmcnt(8)
    v_mfma_f32_16x16x32_bf16 v[170:173], v[118:121], v[230:233], 0
    ds_read_b64 v[122:123], v32 offset:0
    ds_read_b64 v[124:125], v32 offset:8
    s_waitcnt vmcnt(0)
    ds_write_b32 v26, v27
    v_mfma_f32_16x16x32_bf16 v[178:181], v[50:53], v[230:233], 0
    ds_read_b64 v[126:127], v32 offset:16
    ds_read_b64 v[128:129], v32 offset:24
    v_mfma_f32_16x16x32_bf16 v[194:197], v[230:233], v[34:37], 0
    ds_read_b64 v[130:131], v32 offset:128
    ds_read_b64 v[132:133], v32 offset:136
    v_mfma_f32_16x16x32_bf16 v[198:201], v[230:233], v[38:41], 0
    ds_read_b64 v[134:135], v32 offset:144
    ds_read_b64 v[136:137], v32 offset:152
    v_mfma_f32_16x16x32_bf16 v[210:213], v[230:233], v[42:45], 0
    ds_read_b128 v[230:233], v25 offset:2432
    ds_read_b64 v[138:139], v32 offset:256
    ds_read_b64 v[140:141], v32 offset:264
    v_mfma_f32_16x16x32_bf16 v[202:205], v[234:237], v[34:37], 0
    ds_read_b64 v[142:143], v32 offset:272
    ds_read_b64 v[144:145], v32 offset:280
    v_mfma_f32_16x16x32_bf16 v[206:209], v[234:237], v[38:41], 0
    ds_read2_b32 v[146:147], v33 offset0:0 offset1:1
    ds_read2_b32 v[148:149], v33 offset0:2 offset1:3
    v_mfma_f32_16x16x32_bf16 v[214:217], v[234:237], v[46:49], 0
    ds_read_b128 v[234:237], v25 offset:2944
    ds_read2_b32 v[150:151], v33 offset0:16 offset1:17
    ds_read2_b32 v[152:153], v33 offset0:18 offset1:19
    s_waitcnt lgkmcnt(14)
    v_mfma_f32_16x16x32_bf16 v[162:165], v[58:61], v[238:241], v[162:165]
    ds_read2_b32 v[154:155], v33 offset0:32 offset1:33
    ds_read2_b32 v[156:157], v33 offset0:34 offset1:35
    v_mfma_f32_16x16x32_bf16 v[166:169], v[90:93], v[238:241], v[166:169]
    ds_read_b128 v[238:241], v25 offset:3456
    ds_read2_b32 v[158:159], v33 offset0:48 offset1:49
    ds_read2_b32 v[160:161], v33 offset0:50 offset1:51
    v_mfma_f32_16x16x32_bf16 v[166:169], v[58:61], v[242:245], v[166:169]
    ds_read2_b32 v[62:63], v31 offset0:96 offset1:97
    v_cvt_pk_bf16_f32 v218, v197, v201
    v_mfma_f32_16x16x32_bf16 v[170:173], v[90:93], v[242:245], v[170:173]
    ds_read_b128 v[242:245], v25 offset:3968
    ds_read2_b32 v[64:65], v31 offset0:98 offset1:99
    v_cvt_pk_bf16_f32 v220, v196, v200
    v_mfma_f32_16x16x32_bf16 v[170:173], v[58:61], v[246:249], v[170:173]
    ds_read2_b32 v[94:95], v30 offset0:96 offset1:97
    v_cvt_pk_bf16_f32 v222, v195, v199
    v_mfma_f32_16x16x32_bf16 v[174:177], v[90:93], v[246:249], 0
    ds_read_b128 v[246:249], v25 offset:960
    ds_read2_b32 v[96:97], v30 offset0:98 offset1:99
    v_cvt_pk_bf16_f32 v224, v194, v198
    v_mfma_f32_16x16x32_bf16 v[174:177], v[58:61], v[250:253], v[174:177]
    ds_read2_b32 v[66:67], v31 offset0:80 offset1:81
    v_cvt_pk_bf16_f32 v219, v205, v209
    v_mfma_f32_16x16x32_bf16 v[178:181], v[90:93], v[250:253], v[178:181]
    ds_read_b128 v[250:253], v25 offset:944
    ds_read2_b32 v[68:69], v31 offset0:82 offset1:83
    v_cvt_pk_bf16_f32 v221, v204, v208
    s_waitcnt lgkmcnt(14)
    v_mfma_f32_16x16x32_bf16 v[178:181], v[58:61], v[230:233], v[178:181]
    ds_read2_b32 v[98:99], v30 offset0:80 offset1:81
    v_cvt_pk_bf16_f32 v223, v203, v207
    v_mfma_f32_16x16x32_bf16 v[182:185], v[90:93], v[230:233], 0
    ds_read_b128 v[230:233], v25 offset:320
    ds_read2_b32 v[100:101], v30 offset0:82 offset1:83
    v_cvt_pk_bf16_f32 v225, v202, v206
    v_mfma_f32_16x16x32_bf16 v[182:185], v[58:61], v[234:237], v[182:185]
    ds_read2_b32 v[70:71], v31 offset0:64 offset1:65
    v_cvt_pk_bf16_f32 v226, v213, v217
    v_mfma_f32_16x16x32_bf16 v[186:189], v[90:93], v[234:237], 0
    ds_read_b128 v[234:237], v25 offset:832
    ds_read2_b32 v[72:73], v31 offset0:66 offset1:67
    v_cvt_pk_bf16_f32 v227, v212, v216
    s_waitcnt lgkmcnt(14)
    v_mfma_f32_16x16x32_bf16 v[186:189], v[58:61], v[238:241], v[186:189]
    ds_read2_b32 v[102:103], v30 offset0:64 offset1:65
    v_cvt_pk_bf16_f32 v228, v211, v215
    v_mfma_f32_16x16x32_bf16 v[190:193], v[90:93], v[238:241], 0
    ds_read_b128 v[238:241], v25 offset:1344
    ds_read2_b32 v[104:105], v30 offset0:66 offset1:67
    v_cvt_pk_bf16_f32 v229, v210, v214
    s_waitcnt lgkmcnt(14)
    v_mfma_f32_16x16x32_bf16 v[190:193], v[58:61], v[242:245], v[190:193]
    ds_read_b128 v[242:245], v25 offset:1856
    ds_read2_b32 v[74:75], v31 offset0:48 offset1:49
    v_mfma_f32_16x16x32_bf16 v[170:173], v[218:221], v[122:125], v[170:173]
    ds_read2_b32 v[76:77], v31 offset0:50 offset1:51
    v_mfma_f32_16x16x32_bf16 v[170:173], v[222:225], v[126:129], v[170:173]
    ds_read2_b32 v[106:107], v30 offset0:48 offset1:49
    v_mfma_f32_16x16x32_bf16 v[174:177], v[218:221], v[130:133], v[174:177]
    ds_read2_b32 v[108:109], v30 offset0:50 offset1:51
    v_mfma_f32_16x16x32_bf16 v[174:177], v[222:225], v[134:137], v[174:177]
    ds_read2_b32 v[78:79], v31 offset0:32 offset1:33
    v_mfma_f32_16x16x32_bf16 v[178:181], v[218:221], v[138:141], v[178:181]
    ds_read2_b32 v[80:81], v31 offset0:34 offset1:35
    v_mfma_f32_16x16x32_bf16 v[178:181], v[222:225], v[142:145], v[178:181]
    ds_read2_b32 v[110:111], v30 offset0:32 offset1:33
    v_mfma_f32_16x16x32_bf16 v[178:181], v[226:229], v[146:149], v[178:181]
    ds_read2_b32 v[112:113], v30 offset0:34 offset1:35
    v_mfma_f32_16x16x32_bf16 v[182:185], v[226:229], v[150:153], v[182:185]
    ds_read2_b32 v[82:83], v31 offset0:16 offset1:17
    v_mfma_f32_16x16x32_bf16 v[186:189], v[226:229], v[154:157], v[186:189]
    ds_read2_b32 v[84:85], v31 offset0:18 offset1:19
    v_mfma_f32_16x16x32_bf16 v[190:193], v[226:229], v[158:161], v[190:193]
    ds_read2_b32 v[114:115], v30 offset0:16 offset1:17
    s_waitcnt lgkmcnt(14)
    v_mfma_f32_16x16x32_bf16 v[166:169], v[54:57], v[246:249], v[166:169]
    ds_read2_b32 v[116:117], v30 offset0:18 offset1:19
    v_mfma_f32_16x16x32_bf16 v[170:173], v[86:89], v[246:249], v[170:173]
    v_mfma_f32_16x16x32_bf16 v[174:177], v[118:121], v[246:249], v[174:177]
    v_mfma_f32_16x16x32_bf16 v[182:185], v[50:53], v[246:249], v[182:185]
    v_mfma_f32_16x16x32_bf16 v[194:197], v[246:249], v[34:37], 0
    v_mfma_f32_16x16x32_bf16 v[198:201], v[246:249], v[38:41], 0
    v_mfma_f32_16x16x32_bf16 v[210:213], v[246:249], v[42:45], 0
    ds_read_b128 v[246:249], v25 offset:2368
    v_mfma_f32_16x16x32_bf16 v[202:205], v[250:253], v[34:37], 0
    v_mfma_f32_16x16x32_bf16 v[206:209], v[250:253], v[38:41], 0
    v_mfma_f32_16x16x32_bf16 v[214:217], v[250:253], v[46:49], 0
    ds_read_b128 v[250:253], v25 offset:2880
    v_mfma_f32_16x16x32_bf16 v[162:165], v[62:65], v[230:233], v[162:165]
    v_mfma_f32_16x16x32_bf16 v[166:169], v[94:97], v[230:233], v[166:169]
    ds_read_b128 v[230:233], v25 offset:3392
    v_mfma_f32_16x16x32_bf16 v[166:169], v[62:65], v[234:237], v[166:169]
    v_cvt_pk_bf16_f32 v218, v197, v201
    v_mfma_f32_16x16x32_bf16 v[170:173], v[94:97], v[234:237], v[170:173]
    ds_read_b128 v[234:237], v25 offset:3904
    v_cvt_pk_bf16_f32 v220, v196, v200
    s_waitcnt lgkmcnt(14)
    v_mfma_f32_16x16x32_bf16 v[170:173], v[62:65], v[238:241], v[170:173]
    s_waitcnt lgkmcnt(4)
    v_mov_b32 v1, v117
    s_add_u32 m0, s72, 0
    s_add_u32 s74, s70, 0
    s_and_b32 s74, s74, 0x1fffff
    buffer_load_dwordx4 v24, s[56:59], s74 offen lds
    v_cvt_pk_bf16_f32 v222, v195, v199
    v_mfma_f32_16x16x32_bf16 v[174:177], v[94:97], v[238:241], v[174:177]
    ds_read_b128 v[238:241], v25 offset:1472
    v_cvt_pk_bf16_f32 v224, v194, v198
    v_mfma_f32_16x16x32_bf16 v[174:177], v[62:65], v[242:245], v[174:177]
    v_cvt_pk_bf16_f32 v219, v205, v209
    v_mfma_f32_16x16x32_bf16 v[178:181], v[94:97], v[242:245], v[178:181]
    ds_read_b128 v[242:245], v25 offset:1456
    v_cvt_pk_bf16_f32 v221, v204, v208
    s_waitcnt lgkmcnt(5)
    v_mfma_f32_16x16x32_bf16 v[178:181], v[62:65], v[246:249], v[178:181]
    v_cvt_pk_bf16_f32 v223, v203, v207
    v_mfma_f32_16x16x32_bf16 v[182:185], v[94:97], v[246:249], v[182:185]
    ds_read_b128 v[246:249], v25 offset:256
    v_cvt_pk_bf16_f32 v225, v202, v206
    s_waitcnt lgkmcnt(5)
    v_mfma_f32_16x16x32_bf16 v[182:185], v[62:65], v[250:253], v[182:185]
    s_add_u32 m0, s72, 1024
    s_add_u32 s74, s70, 16384
    s_and_b32 s74, s74, 0x1fffff
    buffer_load_dwordx4 v24, s[56:59], s74 offen lds
    v_cvt_pk_bf16_f32 v226, v213, v217
    v_mfma_f32_16x16x32_bf16 v[186:189], v[94:97], v[250:253], v[186:189]
    ds_read_b128 v[250:253], v25 offset:768
    v_cvt_pk_bf16_f32 v227, v212, v216
    s_waitcnt lgkmcnt(5)
    v_mfma_f32_16x16x32_bf16 v[186:189], v[62:65], v[230:233], v[186:189]
    v_cvt_pk_bf16_f32 v228, v211, v215
    v_mfma_f32_16x16x32_bf16 v[190:193], v[94:97], v[230:233], v[190:193]
    ds_read_b128 v[230:233], v25 offset:1280
    v_cvt_pk_bf16_f32 v229, v210, v214
    s_waitcnt lgkmcnt(5)
    v_mfma_f32_16x16x32_bf16 v[190:193], v[62:65], v[234:237], v[190:193]
    ds_read_b128 v[234:237], v25 offset:1792
    v_mfma_f32_16x16x32_bf16 v[174:177], v[218:221], v[122:125], v[174:177]
    v_mfma_f32_16x16x32_bf16 v[174:177], v[222:225], v[126:129], v[174:177]
    s_add_u32 m0, s72, 2048
    s_add_u32 s74, s70, 32768
    s_and_b32 s74, s74, 0x1fffff
    buffer_load_dwordx4 v24, s[56:59], s74 offen lds
    v_mfma_f32_16x16x32_bf16 v[178:181], v[218:221], v[130:133], v[178:181]
    v_mfma_f32_16x16x32_bf16 v[178:181], v[222:225], v[134:137], v[178:181]
    v_mfma_f32_16x16x32_bf16 v[182:185], v[218:221], v[138:141], v[182:185]
    v_mfma_f32_16x16x32_bf16 v[182:185], v[222:225], v[142:145], v[182:185]
    v_mfma_f32_16x16x32_bf16 v[182:185], v[226:229], v[146:149], v[182:185]
    v_mfma_f32_16x16x32_bf16 v[186:189], v[226:229], v[150:153], v[186:189]
    s_add_u32 m0, s72, 3072
    s_add_u32 s74, s70, 49152
    s_and_b32 s74, s74, 0x1fffff
    buffer_load_dwordx4 v24, s[56:59], s74 offen lds
    v_mfma_f32_16x16x32_bf16 v[190:193], v[226:229], v[154:157], v[190:193]
    s_waitcnt lgkmcnt(5)
    v_mfma_f32_16x16x32_bf16 v[170:173], v[54:57], v[238:241], v[170:173]
    v_mfma_f32_16x16x32_bf16 v[174:177], v[86:89], v[238:241], v[174:177]
    v_mfma_f32_16x16x32_bf16 v[178:181], v[118:121], v[238:241], v[178:181]
    v_mfma_f32_16x16x32_bf16 v[186:189], v[50:53], v[238:241], v[186:189]
    v_mfma_f32_16x16x32_bf16 v[194:197], v[238:241], v[34:37], 0
    s_add_u32 m0, s72, 4096
    s_add_u32 s74, s70, 65536
    s_and_b32 s74, s74, 0x1fffff
    buffer_load_dwordx4 v24, s[56:59], s74 offen lds
    v_mfma_f32_16x16x32_bf16 v[198:201], v[238:241], v[38:41], 0
    v_mfma_f32_16x16x32_bf16 v[210:213], v[238:241], v[42:45], 0
    ds_read_b128 v[238:241], v25 offset:2304
    s_waitcnt lgkmcnt(5)
    v_mfma_f32_16x16x32_bf16 v[202:205], v[242:245], v[34:37], 0
    v_mfma_f32_16x16x32_bf16 v[206:209], v[242:245], v[38:41], 0
    v_mfma_f32_16x16x32_bf16 v[214:217], v[242:245], v[46:49], 0
    ds_read_b128 v[242:245], v25 offset:2816
    s_waitcnt lgkmcnt(5)
    v_mfma_f32_16x16x32_bf16 v[162:165], v[66:69], v[246:249], v[162:165]
    s_add_u32 m0, s72, 5120
    s_add_u32 s74, s70, 81920
    s_and_b32 s74, s74, 0x1fffff
    buffer_load_dwordx4 v24, s[56:59], s74 offen lds
    v_mfma_f32_16x16x32_bf16 v[166:169], v[98:101], v[246:249], v[166:169]
    ds_read_b128 v[246:249], v25 offset:3328
    s_waitcnt lgkmcnt(5)
    v_mfma_f32_16x16x32_bf16 v[166:169], v[66:69], v[250:253], v[166:169]
    v_cvt_pk_bf16_f32 v218, v197, v201
    v_mfma_f32_16x16x32_bf16 v[170:173], v[98:101], v[250:253], v[170:173]
    ds_read_b128 v[250:253], v25 offset:3840
    v_cvt_pk_bf16_f32 v220, v196, v200
    s_waitcnt lgkmcnt(5)
    v_mfma_f32_16x16x32_bf16 v[170:173], v[66:69], v[230:233], v[170:173]
    v_cvt_pk_bf16_f32 v222, v195, v199
    v_mfma_f32_16x16x32_bf16 v[174:177], v[98:101], v[230:233], v[174:177]
    ds_read_b128 v[230:233], v25 offset:1984
    v_cvt_pk_bf16_f32 v224, v194, v198
    s_waitcnt lgkmcnt(5)
    v_mfma_f32_16x16x32_bf16 v[174:177], v[66:69], v[234:237], v[174:177]
    s_add_u32 m0, s72, 6144
    s_add_u32 s74, s70, 98304
    s_and_b32 s74, s74, 0x1fffff
    buffer_load_dwordx4 v24, s[56:59], s74 offen lds
    v_cvt_pk_bf16_f32 v219, v205, v209
    v_mfma_f32_16x16x32_bf16 v[178:181], v[98:101], v[234:237], v[178:181]
    ds_read_b128 v[234:237], v25 offset:1968
    v_cvt_pk_bf16_f32 v221, v204, v208
    s_waitcnt lgkmcnt(5)
    v_mfma_f32_16x16x32_bf16 v[178:181], v[66:69], v[238:241], v[178:181]
    v_cvt_pk_bf16_f32 v223, v203, v207
    v_mfma_f32_16x16x32_bf16 v[182:185], v[98:101], v[238:241], v[182:185]
    ds_read_b128 v[238:241], v25 offset:192
    v_cvt_pk_bf16_f32 v225, v202, v206
    s_waitcnt lgkmcnt(5)
    v_mfma_f32_16x16x32_bf16 v[182:185], v[66:69], v[242:245], v[182:185]
    v_cvt_pk_bf16_f32 v226, v213, v217
    v_mfma_f32_16x16x32_bf16 v[186:189], v[98:101], v[242:245], v[186:189]
    ds_read_b128 v[242:245], v25 offset:704
    v_cvt_pk_bf16_f32 v227, v212, v216
    s_waitcnt lgkmcnt(5)
    v_mfma_f32_16x16x32_bf16 v[186:189], v[66:69], v[246:249], v[186:189]
    s_add_u32 m0, s72, 7168
    s_add_u32 s74, s70, 114688
    s_and_b32 s74, s74, 0x1fffff
    buffer_load_dwordx4 v24, s[56:59], s74 offen lds
    v_cvt_pk_bf16_f32 v228, v211, v215
    v_mfma_f32_16x16x32_bf16 v[190:193], v[98:101], v[246:249], v[190:193]
    ds_read_b128 v[246:249], v25 offset:1216
    v_cvt_pk_bf16_f32 v229, v210, v214
    s_waitcnt lgkmcnt(5)
    v_mfma_f32_16x16x32_bf16 v[190:193], v[66:69], v[250:253], v[190:193]
    ds_read_b128 v[250:253], v25 offset:1728
    v_mfma_f32_16x16x32_bf16 v[178:181], v[218:221], v[122:125], v[178:181]
    v_mfma_f32_16x16x32_bf16 v[178:181], v[222:225], v[126:129], v[178:181]
    v_mfma_f32_16x16x32_bf16 v[182:185], v[218:221], v[130:133], v[182:185]
    v_mfma_f32_16x16x32_bf16 v[182:185], v[222:225], v[134:137], v[182:185]
    s_add_u32 m0, s72, 8192
    s_add_u32 s74, s70, 131072
    s_and_b32 s74, s74, 0x1fffff
    buffer_load_dwordx4 v24, s[56:59], s74 offen lds
    v_mfma_f32_16x16x32_bf16 v[186:189], v[218:221], v[138:141], v[186:189]
    v_mfma_f32_16x16x32_bf16 v[186:189], v[222:225], v[142:145], v[186:189]
    v_mfma_f32_16x16x32_bf16 v[186:189], v[226:229], v[146:149], v[186:189]
    v_mfma_f32_16x16x32_bf16 v[190:193], v[226:229], v[150:153], v[190:193]
    s_waitcnt lgkmcnt(5)
    v_mfma_f32_16x16x32_bf16 v[174:177], v[54:57], v[230:233], v[174:177]
    v_mfma_f32_16x16x32_bf16 v[178:181], v[86:89], v[230:233], v[178:181]
    s_add_u32 m0, s72, 9216
    s_add_u32 s74, s70, 147456
    s_and_b32 s74, s74, 0x1fffff
    buffer_load_dwordx4 v24, s[56:59], s74 offen lds
    v_mfma_f32_16x16x32_bf16 v[182:185], v[118:121], v[230:233], v[182:185]
    v_mfma_f32_16x16x32_bf16 v[190:193], v[50:53], v[230:233], v[190:193]
    v_mfma_f32_16x16x32_bf16 v[194:197], v[230:233], v[34:37], 0
    v_mfma_f32_16x16x32_bf16 v[198:201], v[230:233], v[38:41], 0
    v_mfma_f32_16x16x32_bf16 v[210:213], v[230:233], v[42:45], 0
    ds_read_b128 v[230:233], v25 offset:2240
    s_waitcnt lgkmcnt(5)
    v_mfma_f32_16x16x32_bf16 v[202:205], v[234:237], v[34:37], 0
    v_mfma_f32_16x16x32_bf16 v[206:209], v[234:237], v[38:41], 0
    v_mfma_f32_16x16x32_bf16 v[214:217], v[234:237], v[46:49], 0
    ds_read_b128 v[234:237], v25 offset:2752
    s_waitcnt lgkmcnt(5)
    v_mfma_f32_16x16x32_bf16 v[162:165], v[70:73], v[238:241], v[162:165]
    v_mfma_f32_16x16x32_bf16 v[166:169], v[102:105], v[238:241], v[166:169]
    ds_read_b128 v[238:241], v25 offset:3264
    s_waitcnt lgkmcnt(5)
    v_mfma_f32_16x16x32_bf16 v[166:169], v[70:73], v[242:245], v[166:169]
    v_cvt_pk_bf16_f32 v218, v197, v201
    v_mfma_f32_16x16x32_bf16 v[170:173], v[102:105], v[242:245], v[170:173]
    ds_read_b128 v[242:245], v25 offset:3776
    v_cvt_pk_bf16_f32 v220, v196, v200
    s_waitcnt lgkmcnt(5)
    v_mfma_f32_16x16x32_bf16 v[170:173], v[70:73], v[246:249], v[170:173]
    v_cvt_pk_bf16_f32 v222, v195, v199
    v_mfma_f32_16x16x32_bf16 v[174:177], v[102:105], v[246:249], v[174:177]
    ds_read_b128 v[246:249], v25 offset:2496
    v_cvt_pk_bf16_f32 v224, v194, v198
    s_waitcnt lgkmcnt(5)
    v_mfma_f32_16x16x32_bf16 v[174:177], v[70:73], v[250:253], v[174:177]
    v_cvt_pk_bf16_f32 v219, v205, v209
    v_mfma_f32_16x16x32_bf16 v[178:181], v[102:105], v[250:253], v[178:181]
    ds_read_b128 v[250:253], v25 offset:2480
    v_cvt_pk_bf16_f32 v221, v204, v208
    s_waitcnt lgkmcnt(5)
    v_mfma_f32_16x16x32_bf16 v[178:181], v[70:73], v[230:233], v[178:181]
    v_cvt_pk_bf16_f32 v223, v203, v207
    v_mfma_f32_16x16x32_bf16 v[182:185], v[102:105], v[230:233], v[182:185]
    ds_read_b128 v[230:233], v25 offset:128
    v_cvt_pk_bf16_f32 v225, v202, v206
    s_waitcnt lgkmcnt(5)
    v_mfma_f32_16x16x32_bf16 v[182:185], v[70:73], v[234:237], v[182:185]
    v_cvt_pk_bf16_f32 v226, v213, v217
    v_mfma_f32_16x16x32_bf16 v[186:189], v[102:105], v[234:237], v[186:189]
    ds_read_b128 v[234:237], v25 offset:640
    v_cvt_pk_bf16_f32 v227, v212, v216
    s_waitcnt lgkmcnt(5)
    v_mfma_f32_16x16x32_bf16 v[186:189], v[70:73], v[238:241], v[186:189]
    v_cvt_pk_bf16_f32 v228, v211, v215
    v_mfma_f32_16x16x32_bf16 v[190:193], v[102:105], v[238:241], v[190:193]
    ds_read_b128 v[238:241], v25 offset:1152
    v_cvt_pk_bf16_f32 v229, v210, v214
    s_waitcnt lgkmcnt(5)
    v_mfma_f32_16x16x32_bf16 v[190:193], v[70:73], v[242:245], v[190:193]
    ds_read_b128 v[242:245], v25 offset:1664
    v_mfma_f32_16x16x32_bf16 v[182:185], v[218:221], v[122:125], v[182:185]
    v_mfma_f32_16x16x32_bf16 v[182:185], v[222:225], v[126:129], v[182:185]
    v_mfma_f32_16x16x32_bf16 v[186:189], v[218:221], v[130:133], v[186:189]
    v_mfma_f32_16x16x32_bf16 v[186:189], v[222:225], v[134:137], v[186:189]
    v_mfma_f32_16x16x32_bf16 v[190:193], v[218:221], v[138:141], v[190:193]
    v_mfma_f32_16x16x32_bf16 v[190:193], v[222:225], v[142:145], v[190:193]
    v_mfma_f32_16x16x32_bf16 v[190:193], v[226:229], v[146:149], v[190:193]
    s_waitcnt lgkmcnt(5)
    v_mfma_f32_16x16x32_bf16 v[178:181], v[54:57], v[246:249], v[178:181]
    v_mfma_f32_16x16x32_bf16 v[182:185], v[86:89], v[246:249], v[182:185]
    v_mfma_f32_16x16x32_bf16 v[186:189], v[118:121], v[246:249], v[186:189]
    v_mfma_f32_16x16x32_bf16 v[194:197], v[246:249], v[34:37], 0
    v_mfma_f32_16x16x32_bf16 v[198:201], v[246:249], v[38:41], 0
    ds_read_b128 v[246:249], v25 offset:2176
    s_waitcnt lgkmcnt(5)
    v_mfma_f32_16x16x32_bf16 v[202:205], v[250:253], v[34:37], 0
    v_mfma_f32_16x16x32_bf16 v[206:209], v[250:253], v[38:41], 0
    ds_read_b128 v[250:253], v25 offset:2688
    s_waitcnt lgkmcnt(5)
    v_mfma_f32_16x16x32_bf16 v[162:165], v[74:77], v[230:233], v[162:165]
    v_mfma_f32_16x16x32_bf16 v[166:169], v[106:109], v[230:233], v[166:169]
    ds_read_b128 v[230:233], v25 offset:3200
    s_waitcnt lgkmcnt(5)
    v_mfma_f32_16x16x32_bf16 v[166:169], v[74:77], v[234:237], v[166:169]
    v_cvt_pk_bf16_f32 v218, v197, v201
    v_mfma_f32_16x16x32_bf16 v[170:173], v[106:109], v[234:237], v[170:173]
    ds_read_b128 v[234:237], v25 offset:3712
    v_cvt_pk_bf16_f32 v220, v196, v200
    s_waitcnt lgkmcnt(5)
    v_mfma_f32_16x16x32_bf16 v[170:173], v[74:77], v[238:241], v[170:173]
    v_cvt_pk_bf16_f32 v222, v195, v199
    v_mfma_f32_16x16x32_bf16 v[174:177], v[106:109], v[238:241], v[174:177]
    ds_read_b128 v[238:241], v25 offset:3008
    v_cvt_pk_bf16_f32 v224, v194, v198
    s_waitcnt lgkmcnt(5)
    v_mfma_f32_16x16x32_bf16 v[174:177], v[74:77], v[242:245], v[174:177]
    v_cvt_pk_bf16_f32 v219, v205, v209
    v_mfma_f32_16x16x32_bf16 v[178:181], v[106:109], v[242:245], v[178:181]
    ds_read_b128 v[242:245], v25 offset:2992
    v_cvt_pk_bf16_f32 v221, v204, v208
    s_waitcnt lgkmcnt(5)
    v_mfma_f32_16x16x32_bf16 v[178:181], v[74:77], v[246:249], v[178:181]
    v_cvt_pk_bf16_f32 v223, v203, v207
    v_mfma_f32_16x16x32_bf16 v[182:185], v[106:109], v[246:249], v[182:185]
    ds_read_b128 v[246:249], v25 offset:64
    v_cvt_pk_bf16_f32 v225, v202, v206
    s_waitcnt lgkmcnt(5)
    v_mfma_f32_16x16x32_bf16 v[182:185], v[74:77], v[250:253], v[182:185]
    v_mfma_f32_16x16x32_bf16 v[186:189], v[106:109], v[250:253], v[186:189]
    ds_read_b128 v[250:253], v25 offset:576
    s_waitcnt lgkmcnt(5)
    v_mfma_f32_16x16x32_bf16 v[186:189], v[74:77], v[230:233], v[186:189]
    v_mfma_f32_16x16x32_bf16 v[190:193], v[106:109], v[230:233], v[190:193]
    ds_read_b128 v[230:233], v25 offset:1088
    s_waitcnt lgkmcnt(5)
    v_mfma_f32_16x16x32_bf16 v[190:193], v[74:77], v[234:237], v[190:193]
    ds_read_b128 v[234:237], v25 offset:1600
    v_mfma_f32_16x16x32_bf16 v[186:189], v[218:221], v[122:125], v[186:189]
    v_mfma_f32_16x16x32_bf16 v[186:189], v[222:225], v[126:129], v[186:189]
    v_mfma_f32_16x16x32_bf16 v[190:193], v[218:221], v[130:133], v[190:193]
    v_mfma_f32_16x16x32_bf16 v[190:193], v[222:225], v[134:137], v[190:193]
    s_waitcnt lgkmcnt(5)
    v_mfma_f32_16x16x32_bf16 v[182:185], v[54:57], v[238:241], v[182:185]
    v_mfma_f32_16x16x32_bf16 v[186:189], v[86:89], v[238:241], v[186:189]
    v_mfma_f32_16x16x32_bf16 v[190:193], v[118:121], v[238:241], v[190:193]
    v_mfma_f32_16x16x32_bf16 v[194:197], v[238:241], v[34:37], 0
    v_mfma_f32_16x16x32_bf16 v[198:201], v[238:241], v[38:41], 0
    ds_read_b128 v[238:241], v25 offset:2112
    s_waitcnt lgkmcnt(5)
    v_mfma_f32_16x16x32_bf16 v[202:205], v[242:245], v[34:37], 0
    v_mfma_f32_16x16x32_bf16 v[206:209], v[242:245], v[38:41], 0
    ds_read_b128 v[242:245], v25 offset:2624
    s_waitcnt lgkmcnt(5)
    v_mfma_f32_16x16x32_bf16 v[162:165], v[78:81], v[246:249], v[162:165]
    v_mfma_f32_16x16x32_bf16 v[166:169], v[110:113], v[246:249], v[166:169]
    ds_read_b128 v[246:249], v25 offset:3136
    s_waitcnt lgkmcnt(5)
    v_mfma_f32_16x16x32_bf16 v[166:169], v[78:81], v[250:253], v[166:169]
    v_cvt_pk_bf16_f32 v218, v197, v201
    v_mfma_f32_16x16x32_bf16 v[170:173], v[110:113], v[250:253], v[170:173]
    ds_read_b128 v[250:253], v25 offset:3648
    v_cvt_pk_bf16_f32 v220, v196, v200
    s_waitcnt lgkmcnt(5)
    v_mfma_f32_16x16x32_bf16 v[170:173], v[78:81], v[230:233], v[170:173]
    v_cvt_pk_bf16_f32 v222, v195, v199
    v_mfma_f32_16x16x32_bf16 v[174:177], v[110:113], v[230:233], v[174:177]
    ds_read_b128 v[230:233], v25 offset:3520
    v_cvt_pk_bf16_f32 v224, v194, v198
    s_waitcnt lgkmcnt(5)
    v_mfma_f32_16x16x32_bf16 v[174:177], v[78:81], v[234:237], v[174:177]
    v_cvt_pk_bf16_f32 v219, v205, v209
    v_mfma_f32_16x16x32_bf16 v[178:181], v[110:113], v[234:237], v[178:181]
    ds_read_b128 v[234:237], v25 offset:0
    v_cvt_pk_bf16_f32 v221, v204, v208
    s_waitcnt lgkmcnt(5)
    v_mfma_f32_16x16x32_bf16 v[178:181], v[78:81], v[238:241], v[178:181]
    v_cvt_pk_bf16_f32 v223, v203, v207
    v_mfma_f32_16x16x32_bf16 v[182:185], v[110:113], v[238:241], v[182:185]
    ds_read_b128 v[238:241], v25 offset:512
    v_cvt_pk_bf16_f32 v225, v202, v206
    s_waitcnt lgkmcnt(5)
    v_mfma_f32_16x16x32_bf16 v[182:185], v[78:81], v[242:245], v[182:185]
    v_mfma_f32_16x16x32_bf16 v[186:189], v[110:113], v[242:245], v[186:189]
    ds_read_b128 v[242:245], v25 offset:1024
    s_waitcnt lgkmcnt(5)
    v_mfma_f32_16x16x32_bf16 v[186:189], v[78:81], v[246:249], v[186:189]
    v_mfma_f32_16x16x32_bf16 v[190:193], v[110:113], v[246:249], v[190:193]
    ds_read_b128 v[246:249], v25 offset:1536
    s_waitcnt lgkmcnt(5)
    v_mfma_f32_16x16x32_bf16 v[190:193], v[78:81], v[250:253], v[190:193]
    ds_read_b128 v[250:253], v25 offset:2048
    v_mfma_f32_16x16x32_bf16 v[190:193], v[218:221], v[122:125], v[190:193]
    v_mfma_f32_16x16x32_bf16 v[190:193], v[222:225], v[126:129], v[190:193]
    s_waitcnt lgkmcnt(5)
    v_mfma_f32_16x16x32_bf16 v[186:189], v[54:57], v[230:233], v[186:189]
    v_mfma_f32_16x16x32_bf16 v[190:193], v[86:89], v[230:233], v[190:193]
    ds_read_b128 v[230:233], v25 offset:2560
    s_waitcnt lgkmcnt(5)
    v_mfma_f32_16x16x32_bf16 v[162:165], v[82:85], v[234:237], v[162:165]
    v_mfma_f32_16x16x32_bf16 v[166:169], v[114:117], v[234:237], v[166:169]
    ds_read_b128 v[234:237], v25 offset:3072
    s_waitcnt lgkmcnt(5)
    v_mfma_f32_16x16x32_bf16 v[166:169], v[82:85], v[238:241], v[166:169]
    v_mfma_f32_16x16x32_bf16 v[170:173], v[114:117], v[238:241], v[170:173]
    ds_read_b128 v[238:241], v25 offset:3584
    s_waitcnt lgkmcnt(5)
    v_mfma_f32_16x16x32_bf16 v[170:173], v[82:85], v[242:245], v[170:173]
    v_mfma_f32_16x16x32_bf16 v[174:177], v[114:117], v[242:245], v[174:177]
    ds_read_b128 v[242:245], v25 offset:4032
    s_waitcnt lgkmcnt(5)
    v_mfma_f32_16x16x32_bf16 v[174:177], v[82:85], v[246:249], v[174:177]
    v_mfma_f32_16x16x32_bf16 v[178:181], v[114:117], v[246:249], v[178:181]
    s_waitcnt lgkmcnt(4)
    v_mfma_f32_16x16x32_bf16 v[178:181], v[82:85], v[250:253], v[178:181]
    v_mfma_f32_16x16x32_bf16 v[182:185], v[114:117], v[250:253], v[182:185]
    s_waitcnt lgkmcnt(3)
    v_mfma_f32_16x16x32_bf16 v[182:185], v[82:85], v[230:233], v[182:185]
    v_mfma_f32_16x16x32_bf16 v[186:189], v[114:117], v[230:233], v[186:189]
    s_waitcnt lgkmcnt(2)
    v_mfma_f32_16x16x32_bf16 v[186:189], v[82:85], v[234:237], v[186:189]
    v_mfma_f32_16x16x32_bf16 v[190:193], v[114:117], v[234:237], v[190:193]
    s_waitcnt lgkmcnt(1)
    v_mfma_f32_16x16x32_bf16 v[190:193], v[82:85], v[238:241], v[190:193]
    s_waitcnt lgkmcnt(0)
    v_mfma_f32_16x16x32_bf16 v[190:193], v[54:57], v[242:245], v[190:193]
    v_and_b32 v1, 15, v0
    v_lshlrev_b32 v1, 4, v1
    v_bfe_u32 v2, v0, 4, 1
    v_lshl_add_u32 v1, v2, 9, v1
    v_lshrrev_b32 v2, 5, v0
    v_lshl_add_u32 v1, v2, 8, v1
    s_lshl_b32 s40, s71, 12
    s_add_u32 s40, s40, 4194304
    v_cvt_pk_bf16_f32 v54, v162, v163
    v_cvt_pk_bf16_f32 v55, v164, v165
    v_cvt_pk_bf16_f32 v56, v166, v167
    v_cvt_pk_bf16_f32 v57, v168, v169
    s_nop 0
    v_permlane16_swap_b32 v54, v56
    v_permlane16_swap_b32 v55, v57
    v_cvt_pk_bf16_f32 v58, v170, v171
    v_cvt_pk_bf16_f32 v59, v172, v173
    v_cvt_pk_bf16_f32 v60, v174, v175
    v_cvt_pk_bf16_f32 v61, v176, v177
    s_nop 0
    v_permlane16_swap_b32 v58, v60
    v_permlane16_swap_b32 v59, v61
    v_cvt_pk_bf16_f32 v62, v178, v179
    v_cvt_pk_bf16_f32 v63, v180, v181
    v_cvt_pk_bf16_f32 v64, v182, v183
    v_cvt_pk_bf16_f32 v65, v184, v185
    s_nop 0
    v_permlane16_swap_b32 v62, v64
    v_permlane16_swap_b32 v63, v65
    v_cvt_pk_bf16_f32 v66, v186, v187
    v_cvt_pk_bf16_f32 v67, v188, v189
    v_cvt_pk_bf16_f32 v68, v190, v191
    v_cvt_pk_bf16_f32 v69, v192, v193
    s_nop 0
    v_permlane16_swap_b32 v66, v68
    v_permlane16_swap_b32 v67, v69
    buffer_store_dwordx4 v[54:57], v1, s[32:35], s40 offen offset:0 sc1
    buffer_store_dwordx4 v[58:61], v1, s[32:35], s40 offen offset:1024 sc1
    buffer_store_dwordx4 v[62:65], v1, s[32:35], s40 offen offset:2048 sc1
    buffer_store_dwordx4 v[66:69], v1, s[32:35], s40 offen offset:3072 sc1
    v_mov_b32 v2, 2
    s_waitcnt vmcnt(4)
    ds_write_b32 v26, v2
    s_lshr_b32 s41, s71, 6
    s_lshl_b32 s41, s41, 4
    v_add_u32 v1, s41, v0
    v_mul_u32_u24 v1, 128, v1
    v_add_u32 v1, 15204352, v1
    v_lshrrev_b32 v2, 4, v0
    v_lshlrev_b32 v16, 12, v2
    v_and_b32 v17, 7, v0
    v_xor_b32 v2, v2, v17
    v_lshl_add_u32 v16, v2, 4, v16
    v_bfe_u32 v2, v0, 3, 1
    v_lshl_add_u32 v16, v2, 8, v16
    s_lshl_b32 s40, s39, 18
    s_lshr_b32 s41, s38, 1
    s_lshl_b32 s41, s41, 9
    s_add_u32 s40, s40, s41
    s_and_b32 s41, s38, 1
    s_lshl_b32 s41, s41, 7
    s_add_u32 s40, s40, s41
    v_add_u32 v16, s40, v16
    v_xor_b32 v17, 64, v16
    s_waitcnt vmcnt(0)
    s_mov_b64 exec, 0xffff
    buffer_atomic_add v27, v1, s[32:35], 0 offen sc1
    s_mov_b64 exec, -1
    s_cmp_lg_u32 s68, 0
    s_cbranch_scc1 L_ldone
    s_sleep 24
    s_mov_b32 s43, 0
L_l3:
    s_sleep 8
    s_mov_b64 exec, 1
    v_mov_b32 v20, 0
    buffer_atomic_add v20, v18, s[32:35], 0 offen sc0 sc1
    ds_read_b128 v[70:73], v19 offset:0
    s_add_u32 s43, s43, 1
    s_cmp_gt_u32 s43, 40000
    s_waitcnt vmcnt(0) lgkmcnt(0)
    s_cbranch_scc1 L_l3d
    v_min_u32 v70, v70, v71
    v_min3_u32 v70, v70, v72, v73
    v_lshlrev_b32 v70, 5, v70
    v_min_u32 v70, v70, v20
    v_cmp_gt_u32 vcc, 64, v70
    s_cbranch_vccnz L_l3
L_l3d:
    s_mov_b64 exec, -1
    s_mov_b32 m0, 512
    s_mov_b32 s74, 4194304
    buffer_load_dwordx4 v16, s[32:35], s74 offen offset:0 sc1 lds
    s_mov_b32 s74, 4209664
    buffer_load_dwordx4 v17, s[32:35], s74 offen offset:1024 sc1 lds
    s_mov_b32 s74, 4225024
    buffer_load_dwordx4 v16, s[32:35], s74 offen offset:2048 sc1 lds
    s_mov_b32 s74, 4240384
    buffer_load_dwordx4 v17, s[32:35], s74 offen offset:3072 sc1 lds
    s_mov_b32 m0, 5120
    s_mov_b32 s74, 4259840
    buffer_load_dwordx4 v16, s[32:35], s74 offen offset:0 sc1 lds
    s_mov_b32 s74, 4275200
    buffer_load_dwordx4 v17, s[32:35], s74 offen offset:1024 sc1 lds
    s_mov_b32 s74, 4290560
    buffer_load_dwordx4 v16, s[32:35], s74 offen offset:2048 sc1 lds
    s_mov_b32 s74, 4305920
    buffer_load_dwordx4 v17, s[32:35], s74 offen offset:3072 sc1 lds
    s_mov_b32 m0, 9728
    s_mov_b32 s74, 4325376
    buffer_load_dwordx4 v16, s[32:35], s74 offen offset:0 sc1 lds
    s_mov_b32 s74, 4340736
    buffer_load_dwordx4 v17, s[32:35], s74 offen offset:1024 sc1 lds
    s_mov_b32 s74, 4356096
    buffer_load_dwordx4 v16, s[32:35], s74 offen offset:2048 sc1 lds
    s_mov_b32 s74, 4371456
    buffer_load_dwordx4 v17, s[32:35], s74 offen offset:3072 sc1 lds
    s_mov_b32 m0, 14336
    s_mov_b32 s74, 4390912
    buffer_load_dwordx4 v16, s[32:35], s74 offen offset:0 sc1 lds
    s_mov_b32 s74, 4406272
    buffer_load_dwordx4 v17, s[32:35], s74 offen offset:1024 sc1 lds
    s_mov_b32 s74, 4421632
    buffer_load_dwordx4 v16, s[32:35], s74 offen offset:2048 sc1 lds
    s_mov_b32 s74, 4436992
    buffer_load_dwordx4 v17, s[32:35], s74 offen offset:3072 sc1 lds
    v_mov_b32 v70, 3
    v_mov_b32 v71, 3
    v_mov_b32 v72, 3
    v_mov_b32 v73, 3
    s_waitcnt vmcnt(0)
    ds_write_b128 v19, v[70:73] offset:0
    s_waitcnt lgkmcnt(0)
L_ldone:
    s_endpgm
L_compute:
    s_lshr_b32 s52, s3, 1
    s_and_b32 s53, s3, 1
    s_lshl_b32 s54, s37, 1
    s_add_u32 s54, s54, s53
    s_lshl_b32 s40, s36, 1
    s_add_u32 s40, s40, s52
    s_lshl_b32 s40, s40, 5
    s_add_u32 s59, s40, s54
    s_getpc_b64 s[64:65]
L_pcref:
    s_sub_u32 s64, s64, L_pcref-gated_mix__ssm_conv_s4d__linear_attn_block__prompt_kernel
    s_subb_u32 s65, s65, 0
    s_lshr_b32 s40, s2, 3
    s_lshl_b32 s40, s40, 2
    s_add_u32 s40, s40, s3
    s_lshl_b32 s40, s40, 8
    v_lshl_add_u32 v1, v0, 2, s40
    v_min_u32 v1, L_codeend-gated_mix__ssm_conv_s4d__linear_attn_block__prompt_kernel-4, v1
    global_load_dword v246, v1, s[64:65]
    s_lshl_b32 s40, s54, 4
    v_add_u32 v6, s40, v0
    v_mul_u32_u24 v6, 128, v6
    v_add_u32 v6, 14680064, v6
    s_add_u32 s40, s40, s36
    s_mul_i32 s40, s40, 128
    s_add_u32 s40, s40, 14680064
    v_mov_b32 v4, s40
    s_lshl_b32 s40, s36, 1
    s_add_u32 s40, s40, s52
    s_lshl_b32 s40, s40, 4
    v_add_u32 v7, s40, v0
    v_mul_u32_u24 v7, 128, v7
    v_add_u32 v7, 14942208, v7
    s_lshl_b32 s40, s38, 1
    s_add_u32 s40, s40, s52
    s_lshl_b32 s40, s40, 4
    s_add_u32 s40, s40, s39
    s_mul_i32 s40, s40, 128
    s_add_u32 s40, s40, 14942208
    v_mov_b32 v5, s40
    v_mov_b32 v3, 1
    v_mov_b32 v2, 0
    s_lshl_b32 s40, s54, 1
    s_add_u32 s40, s40, s52
    s_lshl_b32 s41, s40, 14
    s_add_u32 s41, s41, 12582912
    v_lshl_add_u32 v12, v0, 4, s41
    s_lshl_b32 s40, s40, 4
    s_add_u32 s40, s40, s36
    s_lshl_b32 s40, s40, 6
    s_add_u32 s40, s40, 13631488
    v_add_u32 v13, s40, v0
    s_lshl_b32 s62, s36, 10
    s_lshl_b32 s40, s39, 4
    s_add_u32 s40, s40, s38
    s_mul_i32 s40, s40, 128
    s_add_u32 s40, s40, 15204352
    v_mov_b32 v58, s40
    s_lshl_b32 s40, s36, 4
    s_add_u32 s40, s40, s37
    s_lshl_b32 s40, s40, 2
    s_add_u32 s40, s40, s3
    s_lshl_b32 s40, s40, 3
    s_add_u32 s40, s40, 14155776
    v_lshrrev_b32 v1, 5, v0
    v_lshl_add_u32 v59, v1, 2, s40
    s_mov_b32 s66, 0x00010001
    s_mov_b32 s67, 0x00010001
    s_mov_b32 s68, 0x80000000
    s_mov_b32 s69, 0x80000000
    v_mov_b32 v70, -1
    v_mov_b32 v71, -1
    v_mov_b32 v72, -1
    v_mov_b32 v73, -1
    s_waitcnt lgkmcnt(0)
    s_mov_b32 s32, s30
    s_mov_b32 s33, s31
    s_mov_b32 s34, 268435456
    s_mov_b32 s35, 0x20000
    s_mov_b32 s48, s26
    s_mov_b32 s49, s27
    s_mov_b32 s50, 4194304
    s_mov_b32 s51, 0x20000
    buffer_store_dwordx4 v[70:73], v12, s[32:35], s62 offen sc1
    s_mov_b64 exec, s[66:67]
    buffer_store_dwordx4 v[70:73], v13, s[32:35], 0 offen sc1
    s_mov_b64 exec, 1
    buffer_store_dword v2, v4, s[32:35], 0 offen sc1
    buffer_store_dword v2, v5, s[32:35], 0 offen sc1
    buffer_store_dword v2, v58, s[32:35], 0 offen sc1
    s_mov_b64 exec, s[68:69]
    buffer_store_dword v70, v59, s[32:35], 0 offen sc1
    s_mov_b64 exec, -1
    s_lshl_b32 s40, s3, 9
    s_add_u32 m0, s40, 30720
    s_lshr_b32 s41, s37, 2
    s_add_u32 s41, s41, s3
    s_and_b32 s41, s41, 3
    s_lshl_b32 s41, s41, 9
    v_lshl_add_u32 v1, v0, 4, s41
    s_mov_b64 exec, 0xffffffff
    global_load_lds_dwordx4 v1, s[24:25]
    s_mov_b64 exec, -1
    s_lshl_b32 s40, s52, 13
    s_add_u32 s40, s40, 40960
    v_and_b32 v1, 15, v0
    v_lshl_add_u32 v60, v1, 7, s40
    v_bfe_u32 v1, v0, 1, 3
    v_lshrrev_b32 v2, 4, v0
    v_xor_b32 v1, v1, v2
    v_lshl_add_u32 v60, v1, 4, v60
    v_xor_b32 v61, 64, v60
    v_lshlrev_b32 v62, 10, v2
    v_bfe_u32 v1, v0, 2, 2
    v_lshl_add_u32 v62, v1, 7, v62
    s_lshl_b32 s40, s53, 1
    v_bfe_u32 v1, v0, 3, 2
    v_xor_b32 v1, s40, v1
    v_lshl_add_u32 v62, v1, 5, v62
    v_and_b32 v1, 3, v0
    v_lshl_add_u32 v62, v1, 3, v62
    v_add_u32 v62, 57344, v62
    v_xor_b32 v63, 32, v62
    s_lshl_b32 s40, s52, 5
    v_xor_b32 v64, s40, v62
    v_xor_b32 v65, 32, v64
    s_lshl_b32 s40, s37, 2
    s_add_u32 s40, s40, s3
    s_and_b32 s41, s40, 7
    s_lshl_b32 s40, s40, 8
    s_add_u32 s40, s40, 40960
    v_lshrrev_b32 v1, 5, v0
    v_lshl_add_u32 v66, v1, 7, s40
    v_bfe_u32 v1, v0, 2, 3
    v_xor_b32 v1, s41, v1
    v_lshl_add_u32 v66, v1, 4, v66
    v_and_b32 v1, 3, v0
    v_lshl_add_u32 v66, v1, 2, v66
    v_and_b32 v1, 31, v0
    v_lshlrev_b32 v67, 2, v1
    v_mov_b32 v58, 0
    s_mov_b32 s55, 0
    s_mov_b32 s56, 0
    v_mov_b32 v150, 0
    v_mov_b32 v151, 0
    v_mov_b32 v152, 0
    v_mov_b32 v153, 0
    v_mov_b32 v154, 0
    v_mov_b32 v155, 0
    v_mov_b32 v156, 0
    v_mov_b32 v157, 0
    v_mov_b32 v158, 0
    v_mov_b32 v159, 0
    v_mov_b32 v160, 0
    v_mov_b32 v161, 0
    v_mov_b32 v162, 0
    v_mov_b32 v163, 0
    v_mov_b32 v164, 0
    v_mov_b32 v165, 0
    v_mov_b32 v166, 0
    v_mov_b32 v167, 0
    v_mov_b32 v168, 0
    v_mov_b32 v169, 0
    v_mov_b32 v170, 0
    v_mov_b32 v171, 0
    v_mov_b32 v172, 0
    v_mov_b32 v173, 0
    v_mov_b32 v174, 0
    v_mov_b32 v175, 0
    v_mov_b32 v176, 0
    v_mov_b32 v177, 0
    v_mov_b32 v178, 0
    v_mov_b32 v179, 0
    v_mov_b32 v180, 0
    v_mov_b32 v181, 0
    v_mov_b32 v182, 0
    v_mov_b32 v183, 0
    v_mov_b32 v184, 0
    v_mov_b32 v185, 0
    v_mov_b32 v186, 0
    v_mov_b32 v187, 0
    v_mov_b32 v188, 0
    v_mov_b32 v189, 0
    v_mov_b32 v190, 0
    v_mov_b32 v191, 0
    v_mov_b32 v192, 0
    v_mov_b32 v193, 0
    v_mov_b32 v194, 0
    v_mov_b32 v195, 0
    v_mov_b32 v196, 0
    v_mov_b32 v197, 0
    v_mov_b32 v198, 0
    v_mov_b32 v199, 0
    v_mov_b32 v200, 0
    v_mov_b32 v201, 0
    v_mov_b32 v202, 0
    v_mov_b32 v203, 0
    v_mov_b32 v204, 0
    v_mov_b32 v205, 0
    v_mov_b32 v206, 0
    v_mov_b32 v207, 0
    v_mov_b32 v208, 0
    v_mov_b32 v209, 0
    v_mov_b32 v210, 0
    v_mov_b32 v211, 0
    v_mov_b32 v212, 0
    v_mov_b32 v213, 0
    v_mov_b32 v214, 0
    v_mov_b32 v215, 0
    v_mov_b32 v216, 0
    v_mov_b32 v217, 0
    v_mov_b32 v218, 0
    v_mov_b32 v219, 0
    v_mov_b32 v220, 0
    v_mov_b32 v221, 0
    v_mov_b32 v222, 0
    v_mov_b32 v223, 0
    v_mov_b32 v224, 0
    v_mov_b32 v225, 0
    v_mov_b32 v226, 0
    v_mov_b32 v227, 0
    v_mov_b32 v228, 0
    v_mov_b32 v229, 0
    v_mov_b32 v230, 0
    v_mov_b32 v231, 0
    v_mov_b32 v232, 0
    v_mov_b32 v233, 0
    v_mov_b32 v234, 0
    v_mov_b32 v235, 0
    v_mov_b32 v236, 0
    v_mov_b32 v237, 0
    v_mov_b32 v238, 0
    v_mov_b32 v239, 0
    v_mov_b32 v240, 0
    v_mov_b32 v241, 0
    v_mov_b32 v242, 0
    v_mov_b32 v243, 0
    v_mov_b32 v244, 0
    v_mov_b32 v245, 0
    s_mov_b32 s60, 0x358637bd
    s_mov_b32 s61, 1069066811
    s_and_b32 s63, s36, 0
    s_lshl_b32 s63, s63, 11
    s_lshl_b32 s40, s3, 11
    s_add_u32 s40, s40, 18432
    v_lshl_add_u32 v10, v0, 4, s40
    s_xor_b32 s40, s3, 2
    s_lshl_b32 s40, s40, 11
    s_add_u32 s40, s40, 18432
    v_lshl_add_u32 v11, v0, 4, s40
    s_lshl_b32 s40, s3, 2
    s_add_u32 s41, s40, 4608
    v_mov_b32 v15, s41
    v_xor_b32 v16, 8, v15
    s_add_u32 s41, s40, 16
    v_mov_b32 v19, s41
    v_xor_b32 v20, 8, v19
    s_lshl_b32 s40, s3, 10
    s_add_u32 s40, s40, 26624
    v_lshl_add_u32 v17, v0, 4, s40
    s_lshl_b32 s40, s53, 10
    s_add_u32 s40, s40, 26624
    v_lshl_add_u32 v18, v0, 4, s40
    s_lshl_b32 s40, s54, 11
    s_add_u32 s40, s40, 13631488
    v_and_b32 v1, 15, v0
    v_lshl_add_u32 v14, v1, 6, s40
    v_lshrrev_b32 v2, 4, v0
    v_lshl_add_u32 v14, v2, 4, v14
    v_lshlrev_b32 v2, 2, v2
    v_sub_u32 v1, v1, v2
    v_mov_b32 v32, 0
    v_mov_b32 v33, 0
    v_mov_b32 v36, 0
    v_mov_b32 v37, 0
    v_mov_b32 v86, 0x3f80
    v_mov_b32 v87, 0x3f800000
    v_cmp_eq_u32 vcc, 0, v1
    s_nop 1
    v_cndmask_b32 v34, 0, v86, vcc
    v_cmp_eq_u32 vcc, 1, v1
    s_nop 1
    v_cndmask_b32 v34, v34, v87, vcc
    v_cmp_eq_u32 vcc, 2, v1
    s_nop 1
    v_cndmask_b32 v35, 0, v86, vcc
    v_cmp_eq_u32 vcc, 3, v1
    s_nop 1
    v_cndmask_b32 v35, v35, v87, vcc
    v_mov_b32 v38, 0x3f803f80
    v_mov_b32 v39, 0x3f803f80
    v_mov_b32 v40, 0x3f803f80
    v_mov_b32 v41, 0x3f803f80
    s_lshl_b32 s40, s36, 1
    s_add_u32 s40, s40, s52
    s_lshl_b32 s40, s40, 7
    s_add_u32 s40, s40, s54
    s_lshl_b32 s40, s40, 10
    s_add_u32 s40, s40, 8388608
    v_lshl_add_u32 v21, v0, 4, s40
    v_lshrrev_b32 v1, 2, v0
    v_lshlrev_b32 v26, 7, v1
    v_bfe_u32 v1, v0, 3, 2
    v_lshl_add_u32 v26, v1, 5, v26
    v_and_b32 v1, 3, v0
    v_lshl_add_u32 v26, v1, 3, v26
    v_add_u32 v26, 81920, v26
    v_xor_b32 v27, 32, v26
    v_xor_b32 v28, 64, v26
    v_xor_b32 v29, 96, v26
    s_lshl_b32 s40, s38, 2
    s_add_u32 s40, s40, s3
    s_lshl_b32 s41, s40, 16
    s_add_u32 s42, s41, 8388608
    v_lshl_add_u32 v22, v0, 4, s42
    s_lshl_b32 s42, s39, 7
    s_add_u32 s41, s41, s42
    v_and_b32 v1, 15, v0
    v_lshl_add_u32 v25, v1, 11, s41
    v_bfe_u32 v2, v0, 4, 1
    v_lshl_add_u32 v25, v2, 5, v25
    v_lshrrev_b32 v2, 5, v0
    v_lshl_add_u32 v25, v2, 4, v25
    s_lshl_b32 s41, s40, 7
    s_add_u32 s41, s41, 14155776
    v_lshl_add_u32 v23, v1, 2, s41
    v_mov_b32 v24, 0
    v_lshrrev_b32 v1, 2, v0
    v_lshlrev_b32 v30, 8, v1
    v_and_b32 v1, 7, v1
    s_lshl_b32 s40, s3, 1
    v_xor_b32 v1, s40, v1
    v_lshl_add_u32 v30, v1, 4, v30
    v_bfe_u32 v1, v0, 1, 1
    v_lshl_add_u32 v30, v1, 7, v30
    v_and_b32 v1, 1, v0
    v_lshl_add_u32 v30, v1, 3, v30
    v_add_u32 v30, 512, v30
    v_xor_b32 v31, 16, v30
    s_lshl_b32 s44, s44, 11
    s_waitcnt vmcnt(0)
    s_barrier
    ds_read_b128 v[70:73], v60 offset:0
    ds_read_b64_tr_b16 v[102:103], v62 offset:0
    ds_read_b64_tr_b16 v[104:105], v62 offset:512
    ds_read_b64_tr_b16 v[106:107], v63 offset:0
    ds_read_b64_tr_b16 v[108:109], v63 offset:512
    ds_read_b64_tr_b16 v[110:111], v62 offset:8192
    ds_read_b64_tr_b16 v[112:113], v62 offset:8704
    ds_read_b64_tr_b16 v[114:115], v63 offset:8192
    ds_read_b64_tr_b16 v[116:117], v63 offset:8704
    ds_read_b64_tr_b16 v[118:119], v64 offset:16384
    ds_read_b64_tr_b16 v[120:121], v64 offset:16896
    ds_read_b64_tr_b16 v[122:123], v65 offset:16384
    ds_read_b64_tr_b16 v[124:125], v65 offset:16896
    ds_read_b128 v[74:77], v60 offset:2048
    ds_read_b128 v[78:81], v60 offset:4096
    ds_read_b128 v[82:85], v60 offset:6144
    s_waitcnt lgkmcnt(0)
L_gemm:
    v_mfma_f32_16x16x32_bf16 v[150:153], v[102:105], v[70:73], v[150:153]
    ds_read_b128 v[86:89], v61 offset:0
    v_mfma_f32_16x16x32_bf16 v[154:157], v[106:109], v[70:73], v[154:157]
    ds_read_b64_tr_b16 v[126:127], v62 offset:4096
    v_mfma_f32_16x16x32_bf16 v[158:161], v[70:73], v[110:113], v[158:161]
    ds_read_b64_tr_b16 v[128:129], v62 offset:4608
    v_mfma_f32_16x16x32_bf16 v[162:165], v[70:73], v[114:117], v[162:165]
    ds_read_b64_tr_b16 v[130:131], v63 offset:4096
    v_mfma_f32_16x16x32_bf16 v[166:169], v[70:73], v[118:121], v[166:169]
    ds_read_b64_tr_b16 v[132:133], v63 offset:4608
    v_mfma_f32_16x16x32_bf16 v[170:173], v[70:73], v[122:125], v[170:173]
    ds_read_b64_tr_b16 v[134:135], v62 offset:12288
    v_mfma_f32_16x16x32_bf16 v[194:197], v[74:77], v[122:125], v[194:197]
    ds_read_b64_tr_b16 v[136:137], v62 offset:12800
    v_mfma_f32_16x16x32_bf16 v[190:193], v[74:77], v[118:121], v[190:193]
    ds_read_b64_tr_b16 v[138:139], v63 offset:12288
    v_mfma_f32_16x16x32_bf16 v[186:189], v[74:77], v[114:117], v[186:189]
    ds_read_b64_tr_b16 v[140:141], v63 offset:12800
    v_mfma_f32_16x16x32_bf16 v[182:185], v[74:77], v[110:113], v[182:185]
    ds_read_b64_tr_b16 v[142:143], v64 offset:20480
    v_mfma_f32_16x16x32_bf16 v[178:181], v[106:109], v[74:77], v[178:181]
    ds_read_b64_tr_b16 v[144:145], v64 offset:20992
    v_mfma_f32_16x16x32_bf16 v[174:177], v[102:105], v[74:77], v[174:177]
    ds_read_b64_tr_b16 v[146:147], v65 offset:20480
    v_mfma_f32_16x16x32_bf16 v[198:201], v[102:105], v[78:81], v[198:201]
    ds_read_b64_tr_b16 v[148:149], v65 offset:20992
    v_mfma_f32_16x16x32_bf16 v[202:205], v[106:109], v[78:81], v[202:205]
    ds_read_b128 v[90:93], v61 offset:2048
    v_mfma_f32_16x16x32_bf16 v[206:209], v[78:81], v[110:113], v[206:209]
    ds_read_b128 v[94:97], v61 offset:4096
    v_mfma_f32_16x16x32_bf16 v[210:213], v[78:81], v[114:117], v[210:213]
    ds_read_b128 v[98:101], v61 offset:6144
    v_mfma_f32_16x16x32_bf16 v[214:217], v[78:81], v[118:121], v[214:217]
    ds_read_b32 v68, v66
    v_mfma_f32_16x16x32_bf16 v[218:221], v[78:81], v[122:125], v[218:221]
    ds_read_b32 v69, v67 offset:30720
    v_mfma_f32_16x16x32_bf16 v[242:245], v[82:85], v[122:125], v[242:245]
    s_add_u32 s56, s56, 1
    s_mov_b32 s57, 40960
    v_mfma_f32_16x16x32_bf16 v[238:241], v[82:85], v[118:121], v[238:241]
    s_cmp_eq_u32 s56, 3
    s_cselect_b32 s57, 4294885376, s57
    s_cselect_b32 s56, 0, s56
    v_mfma_f32_16x16x32_bf16 v[234:237], v[82:85], v[114:117], v[234:237]
    v_add_u32 v60, s57, v60
    v_mfma_f32_16x16x32_bf16 v[230:233], v[82:85], v[110:113], v[230:233]
    v_add_u32 v61, s57, v61
    v_add_u32 v62, s57, v62
    v_mfma_f32_16x16x32_bf16 v[226:229], v[106:109], v[82:85], v[226:229]
    v_add_u32 v63, s57, v63
    v_mfma_f32_16x16x32_bf16 v[222:225], v[102:105], v[82:85], v[222:225]
    v_add_u32 v64, s57, v64
    v_add_u32 v65, s57, v65
    s_waitcnt lgkmcnt(0)
    v_mfma_f32_16x16x32_bf16 v[150:153], v[126:129], v[86:89], v[150:153]
    v_add_u32 v66, s57, v66
    v_mfma_f32_16x16x32_bf16 v[154:157], v[130:133], v[86:89], v[154:157]
    v_add_u32 v67, 128, v67
    s_barrier
    v_mfma_f32_16x16x32_bf16 v[158:161], v[86:89], v[134:137], v[158:161]
    ds_read_b128 v[70:73], v60 offset:0
    v_mfma_f32_16x16x32_bf16 v[162:165], v[86:89], v[138:141], v[162:165]
    ds_read_b64_tr_b16 v[102:103], v62 offset:0
    v_mfma_f32_16x16x32_bf16 v[166:169], v[86:89], v[142:145], v[166:169]
    ds_read_b64_tr_b16 v[104:105], v62 offset:512
    v_mfma_f32_16x16x32_bf16 v[170:173], v[86:89], v[146:149], v[170:173]
    ds_read_b64_tr_b16 v[106:107], v63 offset:0
    v_mfma_f32_16x16x32_bf16 v[194:197], v[90:93], v[146:149], v[194:197]
    ds_read_b64_tr_b16 v[108:109], v63 offset:512
    v_mfma_f32_16x16x32_bf16 v[190:193], v[90:93], v[142:145], v[190:193]
    ds_read_b64_tr_b16 v[110:111], v62 offset:8192
    v_mfma_f32_16x16x32_bf16 v[186:189], v[90:93], v[138:141], v[186:189]
    ds_read_b64_tr_b16 v[112:113], v62 offset:8704
    v_mfma_f32_16x16x32_bf16 v[182:185], v[90:93], v[134:137], v[182:185]
    ds_read_b64_tr_b16 v[114:115], v63 offset:8192
    v_mfma_f32_16x16x32_bf16 v[178:181], v[130:133], v[90:93], v[178:181]
    ds_read_b64_tr_b16 v[116:117], v63 offset:8704
    v_mfma_f32_16x16x32_bf16 v[174:177], v[126:129], v[90:93], v[174:177]
    ds_read_b64_tr_b16 v[118:119], v64 offset:16384
    v_mfma_f32_16x16x32_bf16 v[198:201], v[126:129], v[94:97], v[198:201]
    ds_read_b64_tr_b16 v[120:121], v64 offset:16896
    v_mfma_f32_16x16x32_bf16 v[202:205], v[130:133], v[94:97], v[202:205]
    ds_read_b64_tr_b16 v[122:123], v65 offset:16384
    v_mfma_f32_16x16x32_bf16 v[206:209], v[94:97], v[134:137], v[206:209]
    ds_read_b64_tr_b16 v[124:125], v65 offset:16896
    v_mfma_f32_16x16x32_bf16 v[210:213], v[94:97], v[138:141], v[210:213]
    ds_read_b128 v[74:77], v60 offset:2048
    v_mfma_f32_16x16x32_bf16 v[214:217], v[94:97], v[142:145], v[214:217]
    ds_read_b128 v[78:81], v60 offset:4096
    v_mfma_f32_16x16x32_bf16 v[218:221], v[94:97], v[146:149], v[218:221]
    ds_read_b128 v[82:85], v60 offset:6144
    v_mfma_f32_16x16x32_bf16 v[242:245], v[98:101], v[146:149], v[242:245]
    v_lshlrev_b32 v1, 16, v68
    v_mfma_f32_16x16x32_bf16 v[238:241], v[98:101], v[142:145], v[238:241]
    v_lshlrev_b32 v2, 16, v69
    v_mfma_f32_16x16x32_bf16 v[234:237], v[98:101], v[138:141], v[234:237]
    v_and_b32 v68, 0xffff0000, v68
    v_and_b32 v69, 0xffff0000, v69
    v_mfma_f32_16x16x32_bf16 v[230:233], v[98:101], v[134:137], v[230:233]
    v_fmac_f32 v58, v1, v2
    v_mfma_f32_16x16x32_bf16 v[226:229], v[130:133], v[98:101], v[226:229]
    v_fmac_f32 v58, v68, v69
    v_mfma_f32_16x16x32_bf16 v[222:225], v[126:129], v[98:101], v[222:225]
    s_add_u32 s55, s55, 1
    s_cmp_lt_u32 s55, 15
    s_waitcnt lgkmcnt(0)
    s_cbranch_scc1 L_gemm
    v_mfma_f32_16x16x32_bf16 v[158:161], v[70:73], v[110:113], v[158:161]
    ds_read_b128 v[86:89], v61 offset:0
    v_mfma_f32_16x16x32_bf16 v[162:165], v[70:73], v[114:117], v[162:165]
    ds_read_b64_tr_b16 v[126:127], v62 offset:4096
    v_mfma_f32_16x16x32_bf16 v[166:169], v[70:73], v[118:121], v[166:169]
    ds_read_b64_tr_b16 v[128:129], v62 offset:4608
    v_mfma_f32_16x16x32_bf16 v[170:173], v[70:73], v[122:125], v[170:173]
    ds_read_b64_tr_b16 v[130:131], v63 offset:4096
    v_mfma_f32_16x16x32_bf16 v[194:197], v[74:77], v[122:125], v[194:197]
    ds_read_b64_tr_b16 v[132:133], v63 offset:4608
    v_mfma_f32_16x16x32_bf16 v[190:193], v[74:77], v[118:121], v[190:193]
    ds_read_b64_tr_b16 v[134:135], v62 offset:12288
    v_mfma_f32_16x16x32_bf16 v[186:189], v[74:77], v[114:117], v[186:189]
    ds_read_b64_tr_b16 v[136:137], v62 offset:12800
    v_mfma_f32_16x16x32_bf16 v[182:185], v[74:77], v[110:113], v[182:185]
    ds_read_b64_tr_b16 v[138:139], v63 offset:12288
    ds_read_b64_tr_b16 v[140:141], v63 offset:12800
    v_mfma_f32_16x16x32_bf16 v[206:209], v[78:81], v[110:113], v[206:209]
    ds_read_b64_tr_b16 v[142:143], v64 offset:20480
    v_mfma_f32_16x16x32_bf16 v[210:213], v[78:81], v[114:117], v[210:213]
    ds_read_b64_tr_b16 v[144:145], v64 offset:20992
    v_mfma_f32_16x16x32_bf16 v[214:217], v[78:81], v[118:121], v[214:217]
    ds_read_b64_tr_b16 v[146:147], v65 offset:20480
    v_mfma_f32_16x16x32_bf16 v[218:221], v[78:81], v[122:125], v[218:221]
    ds_read_b64_tr_b16 v[148:149], v65 offset:20992
    v_mfma_f32_16x16x32_bf16 v[242:245], v[82:85], v[122:125], v[242:245]
    ds_read_b128 v[90:93], v61 offset:2048
    v_mfma_f32_16x16x32_bf16 v[238:241], v[82:85], v[118:121], v[238:241]
    ds_read_b128 v[94:97], v61 offset:4096
    v_mfma_f32_16x16x32_bf16 v[234:237], v[82:85], v[114:117], v[234:237]
    ds_read_b128 v[98:101], v61 offset:6144
    v_mfma_f32_16x16x32_bf16 v[230:233], v[82:85], v[110:113], v[230:233]
    ds_read_b32 v68, v66
    ds_read_b32 v69, v67 offset:30720
    s_mov_b64 exec, 1
    ds_add_u32 v24, v3 offset:4624
    s_mov_b64 exec, -1
    s_waitcnt lgkmcnt(12)
    v_mfma_f32_16x16x32_bf16 v[158:161], v[86:89], v[134:137], v[158:161]
    s_waitcnt lgkmcnt(10)
    v_mfma_f32_16x16x32_bf16 v[162:165], v[86:89], v[138:141], v[162:165]
    s_waitcnt lgkmcnt(8)
    v_mfma_f32_16x16x32_bf16 v[166:169], v[86:89], v[142:145], v[166:169]
    s_waitcnt lgkmcnt(6)
    v_mfma_f32_16x16x32_bf16 v[170:173], v[86:89], v[146:149], v[170:173]
    s_waitcnt lgkmcnt(5)
    v_mfma_f32_16x16x32_bf16 v[194:197], v[90:93], v[146:149], v[194:197]
    v_mfma_f32_16x16x32_bf16 v[190:193], v[90:93], v[142:145], v[190:193]
    v_mfma_f32_16x16x32_bf16 v[186:189], v[90:93], v[138:141], v[186:189]
    v_mfma_f32_16x16x32_bf16 v[182:185], v[90:93], v[134:137], v[182:185]
    s_waitcnt lgkmcnt(4)
    v_mfma_f32_16x16x32_bf16 v[206:209], v[94:97], v[134:137], v[206:209]
    v_mfma_f32_16x16x32_bf16 v[210:213], v[94:97], v[138:141], v[210:213]
    s_waitcnt lgkmcnt(2)
    v_lshlrev_b32 v1, 16, v68
    v_mfma_f32_16x16x32_bf16 v[214:217], v[94:97], v[142:145], v[214:217]
    s_waitcnt lgkmcnt(1)
    v_lshlrev_b32 v2, 16, v69
    v_mfma_f32_16x16x32_bf16 v[218:221], v[94:97], v[146:149], v[218:221]
    v_and_b32 v68, 0xffff0000, v68
    v_mfma_f32_16x16x32_bf16 v[242:245], v[98:101], v[146:149], v[242:245]
    v_mfma_f32_16x16x32_bf16 v[238:241], v[98:101], v[142:145], v[238:241]
    v_and_b32 v69, 0xffff0000, v69
    v_mfma_f32_16x16x32_bf16 v[234:237], v[98:101], v[138:141], v[234:237]
    v_fmac_f32 v58, v1, v2
    v_mfma_f32_16x16x32_bf16 v[230:233], v[98:101], v[134:137], v[230:233]
    v_fmac_f32 v58, v68, v69
    s_setprio 1
    v_mul_f32 v247, s61, v158
    v_mul_f32 v248, s61, v159
    v_mul_f32 v249, s61, v160
    v_mul_f32 v250, s61, v161
    v_exp_f32_e64 v247, v247 clamp
    v_max_f32 v251, s60, v158
    v_exp_f32_e64 v248, v248 clamp
    v_max_f32 v252, s60, v159
    v_exp_f32_e64 v249, v249 clamp
    v_max_f32 v253, s60, v160
    v_exp_f32_e64 v250, v250 clamp
    v_max_f32 v254, s60, v161
    v_add_f32 v247, v247, v251
    v_add_f32 v248, v248, v252
    v_add_f32 v249, v249, v253
    v_add_f32 v250, v250, v254
    v_cvt_pk_bf16_f32 v110, v247, v248
    v_cvt_pk_bf16_f32 v111, v249, v250
    v_mul_f32 v247, s61, v182
    v_mul_f32 v248, s61, v183
    v_mul_f32 v249, s61, v184
    v_mul_f32 v250, s61, v185
    v_exp_f32_e64 v247, v247 clamp
    v_max_f32 v251, s60, v182
    v_exp_f32_e64 v248, v248 clamp
    v_max_f32 v252, s60, v183
    v_exp_f32_e64 v249, v249 clamp
    v_max_f32 v253, s60, v184
    v_exp_f32_e64 v250, v250 clamp
    v_max_f32 v254, s60, v185
    v_add_f32 v247, v247, v251
    v_add_f32 v248, v248, v252
    v_add_f32 v249, v249, v253
    v_add_f32 v250, v250, v254
    v_cvt_pk_bf16_f32 v112, v247, v248
    v_cvt_pk_bf16_f32 v113, v249, v250
    v_cvt_pk_bf16_f32 v118, v166, v167
    v_cvt_pk_bf16_f32 v119, v168, v169
    v_cvt_pk_bf16_f32 v120, v190, v191
    v_cvt_pk_bf16_f32 v121, v192, v193
    v_cvt_pk_bf16_f32 v122, v170, v171
    v_cvt_pk_bf16_f32 v123, v172, v173
    v_cvt_pk_bf16_f32 v124, v194, v195
    v_cvt_pk_bf16_f32 v125, v196, v197
    s_nop 1
    v_mfma_f32_16x16x32_bf16 v[46:49], v[110:113], v[122:125], 0
    v_mfma_f32_16x16x32_bf16 v[42:45], v[110:113], v[118:121], 0
    v_mfma_f32_16x16x32_bf16 v[134:137], v[110:113], v[38:41], 0
    v_mul_f32 v247, s61, v162
    v_mul_f32 v248, s61, v163
    v_mul_f32 v249, s61, v164
    v_mul_f32 v250, s61, v165
    v_exp_f32_e64 v247, v247 clamp
    v_max_f32 v251, s60, v162
    v_exp_f32_e64 v248, v248 clamp
    v_max_f32 v252, s60, v163
    v_exp_f32_e64 v249, v249 clamp
    v_max_f32 v253, s60, v164
    v_exp_f32_e64 v250, v250 clamp
    v_max_f32 v254, s60, v165
    v_add_f32 v247, v247, v251
    v_add_f32 v248, v248, v252
    v_add_f32 v249, v249, v253
    v_add_f32 v250, v250, v254
    v_cvt_pk_bf16_f32 v114, v247, v248
    v_cvt_pk_bf16_f32 v115, v249, v250
    v_mul_f32 v247, s61, v186
    v_mul_f32 v248, s61, v187
    v_mul_f32 v249, s61, v188
    v_mul_f32 v250, s61, v189
    v_exp_f32_e64 v247, v247 clamp
    v_max_f32 v251, s60, v186
    v_exp_f32_e64 v248, v248 clamp
    v_max_f32 v252, s60, v187
    v_exp_f32_e64 v249, v249 clamp
    v_max_f32 v253, s60, v188
    v_exp_f32_e64 v250, v250 clamp
    v_max_f32 v254, s60, v189
    v_add_f32 v247, v247, v251
    v_add_f32 v248, v248, v252
    v_add_f32 v249, v249, v253
    v_add_f32 v250, v250, v254
    v_cvt_pk_bf16_f32 v116, v247, v248
    v_cvt_pk_bf16_f32 v117, v249, v250
    s_nop 1
    v_mfma_f32_16x16x32_bf16 v[54:57], v[114:117], v[122:125], 0
    v_mfma_f32_16x16x32_bf16 v[50:53], v[114:117], v[118:121], 0
    v_mfma_f32_16x16x32_bf16 v[138:141], v[114:117], v[38:41], 0
    v_mul_f32 v247, s61, v206
    v_mul_f32 v248, s61, v207
    v_mul_f32 v249, s61, v208
    v_mul_f32 v250, s61, v209
    v_exp_f32_e64 v247, v247 clamp
    v_max_f32 v251, s60, v206
    v_exp_f32_e64 v248, v248 clamp
    v_max_f32 v252, s60, v207
    v_exp_f32_e64 v249, v249 clamp
    v_max_f32 v253, s60, v208
    v_exp_f32_e64 v250, v250 clamp
    v_max_f32 v254, s60, v209
    v_add_f32 v247, v247, v251
    v_add_f32 v248, v248, v252
    v_add_f32 v249, v249, v253
    v_add_f32 v250, v250, v254
    v_cvt_pk_bf16_f32 v110, v247, v248
    v_cvt_pk_bf16_f32 v111, v249, v250
    v_mul_f32 v247, s61, v230
    v_mul_f32 v248, s61, v231
    v_mul_f32 v249, s61, v232
    v_mul_f32 v250, s61, v233
    v_exp_f32_e64 v247, v247 clamp
    v_max_f32 v251, s60, v230
    v_exp_f32_e64 v248, v248 clamp
    v_max_f32 v252, s60, v231
    v_exp_f32_e64 v249, v249 clamp
    v_max_f32 v253, s60, v232
    v_exp_f32_e64 v250, v250 clamp
    v_max_f32 v254, s60, v233
    v_add_f32 v247, v247, v251
    v_add_f32 v248, v248, v252
    v_add_f32 v249, v249, v253
    v_add_f32 v250, v250, v254
    v_cvt_pk_bf16_f32 v112, v247, v248
    v_cvt_pk_bf16_f32 v113, v249, v250
    v_cvt_pk_bf16_f32 v118, v214, v215
    v_cvt_pk_bf16_f32 v119, v216, v217
    v_cvt_pk_bf16_f32 v120, v238, v239
    v_cvt_pk_bf16_f32 v121, v240, v241
    v_cvt_pk_bf16_f32 v122, v218, v219
    v_cvt_pk_bf16_f32 v123, v220, v221
    v_cvt_pk_bf16_f32 v124, v242, v243
    v_cvt_pk_bf16_f32 v125, v244, v245
    s_nop 1
    v_mfma_f32_16x16x32_bf16 v[46:49], v[110:113], v[122:125], v[46:49]
    v_mfma_f32_16x16x32_bf16 v[42:45], v[110:113], v[118:121], v[42:45]
    v_mfma_f32_16x16x32_bf16 v[134:137], v[110:113], v[38:41], v[134:137]
    v_mul_f32 v247, s61, v210
    v_mul_f32 v248, s61, v211
    v_mul_f32 v249, s61, v212
    v_mul_f32 v250, s61, v213
    v_exp_f32_e64 v247, v247 clamp
    v_max_f32 v251, s60, v210
    v_exp_f32_e64 v248, v248 clamp
    v_max_f32 v252, s60, v211
    v_exp_f32_e64 v249, v249 clamp
    v_max_f32 v253, s60, v212
    v_exp_f32_e64 v250, v250 clamp
    v_max_f32 v254, s60, v213
    v_add_f32 v247, v247, v251
    v_add_f32 v248, v248, v252
    v_add_f32 v249, v249, v253
    v_add_f32 v250, v250, v254
    v_cvt_pk_bf16_f32 v114, v247, v248
    v_cvt_pk_bf16_f32 v115, v249, v250
    v_mul_f32 v247, s61, v234
    v_mul_f32 v248, s61, v235
    v_mul_f32 v249, s61, v236
    v_mul_f32 v250, s61, v237
    v_exp_f32_e64 v247, v247 clamp
    v_max_f32 v251, s60, v234
    v_exp_f32_e64 v248, v248 clamp
    v_max_f32 v252, s60, v235
    v_exp_f32_e64 v249, v249 clamp
    v_max_f32 v253, s60, v236
    v_exp_f32_e64 v250, v250 clamp
    v_max_f32 v254, s60, v237
    v_add_f32 v247, v247, v251
    v_add_f32 v248, v248, v252
    v_add_f32 v249, v249, v253
    v_add_f32 v250, v250, v254
    v_cvt_pk_bf16_f32 v116, v247, v248
    v_cvt_pk_bf16_f32 v117, v249, v250
    s_nop 1
    v_mfma_f32_16x16x32_bf16 v[54:57], v[114:117], v[122:125], v[54:57]
    v_mfma_f32_16x16x32_bf16 v[50:53], v[114:117], v[118:121], v[50:53]
    v_mfma_f32_16x16x32_bf16 v[138:141], v[114:117], v[38:41], v[138:141]
    ds_write_b128 v10, v[46:49]
    v_mfma_f32_16x16x32_bf16 v[150:153], v[102:105], v[70:73], v[150:153]
    v_mfma_f32_16x16x32_bf16 v[154:157], v[106:109], v[70:73], v[154:157]
    v_mfma_f32_16x16x32_bf16 v[178:181], v[106:109], v[74:77], v[178:181]
    v_mfma_f32_16x16x32_bf16 v[174:177], v[102:105], v[74:77], v[174:177]
    s_nop 0
    ds_write_b128 v10, v[54:57] offset:1024
    ds_write_b32 v15, v3
    v_cvt_pk_bf16_f32 v142, v134, v135
    v_cvt_pk_bf16_f32 v143, v136, v137
    v_cvt_pk_bf16_f32 v144, v138, v139
    v_cvt_pk_bf16_f32 v145, v140, v141
    s_mov_b32 s43, 0
L_pw_8:
    ds_read_b32 v1, v16
    ds_read_b128 v[46:49], v11
    ds_read_b128 v[54:57], v11 offset:1024
    s_add_u32 s43, s43, 1
    s_cmp_gt_u32 s43, 400000
    s_waitcnt lgkmcnt(0)
    s_cbranch_scc1 L_pwd_9
    v_cmp_ne_u32 vcc, 1, v1
    s_cbranch_vccnz L_pw_8
L_pwd_9:
    v_add_f32 v42, v42, v46
    v_add_f32 v43, v43, v47
    v_add_f32 v44, v44, v48
    v_add_f32 v45, v45, v49
    v_cvt_pk_bf16_f32 v146, v42, v43
    v_cvt_pk_bf16_f32 v147, v44, v45
    v_add_f32 v50, v50, v54
    v_add_f32 v51, v51, v55
    v_add_f32 v52, v52, v56
    v_add_f32 v53, v53, v57
    v_cvt_pk_bf16_f32 v148, v50, v51
    v_cvt_pk_bf16_f32 v149, v52, v53
    buffer_store_dwordx4 v[146:149], v12, s[32:35], s62 offen sc1
    s_mov_b64 exec, s[66:67]
    buffer_store_dwordx4 v[142:145], v13, s[32:35], 0 offen sc1
    s_mov_b64 exec, 0xffff
    buffer_atomic_add v3, v6, s[32:35], 0 offen sc1
    s_mov_b64 exec, -1
    v_mfma_f32_16x16x32_bf16 v[198:201], v[102:105], v[78:81], v[198:201]
    v_mfma_f32_16x16x32_bf16 v[202:205], v[106:109], v[78:81], v[202:205]
    v_mfma_f32_16x16x32_bf16 v[226:229], v[106:109], v[82:85], v[226:229]
    v_mfma_f32_16x16x32_bf16 v[222:225], v[102:105], v[82:85], v[222:225]
    s_mov_b64 exec, 1
    v_mov_b32 v8, 0
    buffer_atomic_add v8, v4, s[32:35], 0 offen sc0 sc1
    s_mov_b64 exec, -1
    v_mfma_f32_16x16x32_bf16 v[150:153], v[126:129], v[86:89], v[150:153]
    v_mfma_f32_16x16x32_bf16 v[154:157], v[130:133], v[86:89], v[154:157]
    v_mfma_f32_16x16x32_bf16 v[178:181], v[130:133], v[90:93], v[178:181]
    v_mfma_f32_16x16x32_bf16 v[174:177], v[126:129], v[90:93], v[174:177]
    v_mfma_f32_16x16x32_bf16 v[198:201], v[126:129], v[94:97], v[198:201]
    v_mfma_f32_16x16x32_bf16 v[202:205], v[130:133], v[94:97], v[202:205]
    v_mfma_f32_16x16x32_bf16 v[226:229], v[130:133], v[98:101], v[226:229]
    v_mfma_f32_16x16x32_bf16 v[222:225], v[126:129], v[98:101], v[222:225]
    s_nop 0
    v_mul_f32 v247, s61, v150
    v_mul_f32 v248, s61, v151
    v_mul_f32 v249, s61, v152
    v_mul_f32 v250, s61, v153
    v_exp_f32_e64 v247, v247 clamp
    v_max_f32 v251, s60, v150
    v_exp_f32_e64 v248, v248 clamp
    v_max_f32 v252, s60, v151
    v_exp_f32_e64 v249, v249 clamp
    v_max_f32 v253, s60, v152
    v_exp_f32_e64 v250, v250 clamp
    v_max_f32 v254, s60, v153
    v_add_f32 v247, v247, v251
    v_add_f32 v248, v248, v252
    v_add_f32 v249, v249, v253
    v_add_f32 v250, v250, v254
    v_cvt_pk_bf16_f32 v42, v247, v248
    v_cvt_pk_bf16_f32 v43, v249, v250
    v_mul_f32 v247, s61, v154
    v_mul_f32 v248, s61, v155
    v_mul_f32 v249, s61, v156
    v_mul_f32 v250, s61, v157
    v_exp_f32_e64 v247, v247 clamp
    v_max_f32 v251, s60, v154
    v_exp_f32_e64 v248, v248 clamp
    v_max_f32 v252, s60, v155
    v_exp_f32_e64 v249, v249 clamp
    v_max_f32 v253, s60, v156
    v_exp_f32_e64 v250, v250 clamp
    v_max_f32 v254, s60, v157
    v_add_f32 v247, v247, v251
    v_add_f32 v248, v248, v252
    v_add_f32 v249, v249, v253
    v_add_f32 v250, v250, v254
    v_cvt_pk_bf16_f32 v44, v247, v248
    v_cvt_pk_bf16_f32 v45, v249, v250
    v_mul_f32 v247, s61, v174
    v_mul_f32 v248, s61, v175
    v_mul_f32 v249, s61, v176
    v_mul_f32 v250, s61, v177
    v_exp_f32_e64 v247, v247 clamp
    v_max_f32 v251, s60, v174
    v_exp_f32_e64 v248, v248 clamp
    v_max_f32 v252, s60, v175
    v_exp_f32_e64 v249, v249 clamp
    v_max_f32 v253, s60, v176
    v_exp_f32_e64 v250, v250 clamp
    v_max_f32 v254, s60, v177
    v_add_f32 v247, v247, v251
    v_add_f32 v248, v248, v252
    v_add_f32 v249, v249, v253
    v_add_f32 v250, v250, v254
    v_cvt_pk_bf16_f32 v46, v247, v248
    v_cvt_pk_bf16_f32 v47, v249, v250
    v_mul_f32 v247, s61, v178
    v_mul_f32 v248, s61, v179
    v_mul_f32 v249, s61, v180
    v_mul_f32 v250, s61, v181
    v_exp_f32_e64 v247, v247 clamp
    v_max_f32 v251, s60, v178
    v_exp_f32_e64 v248, v248 clamp
    v_max_f32 v252, s60, v179
    v_exp_f32_e64 v249, v249 clamp
    v_max_f32 v253, s60, v180
    v_exp_f32_e64 v250, v250 clamp
    v_max_f32 v254, s60, v181
    v_add_f32 v247, v247, v251
    v_add_f32 v248, v248, v252
    v_add_f32 v249, v249, v253
    v_add_f32 v250, v250, v254
    v_cvt_pk_bf16_f32 v48, v247, v248
    v_cvt_pk_bf16_f32 v49, v249, v250
    v_mul_f32 v247, s61, v198
    v_mul_f32 v248, s61, v199
    v_mul_f32 v249, s61, v200
    v_mul_f32 v250, s61, v201
    v_exp_f32_e64 v247, v247 clamp
    v_max_f32 v251, s60, v198
    v_exp_f32_e64 v248, v248 clamp
    v_max_f32 v252, s60, v199
    v_exp_f32_e64 v249, v249 clamp
    v_max_f32 v253, s60, v200
    v_exp_f32_e64 v250, v250 clamp
    v_max_f32 v254, s60, v201
    v_add_f32 v247, v247, v251
    v_add_f32 v248, v248, v252
    v_add_f32 v249, v249, v253
    v_add_f32 v250, v250, v254
    v_cvt_pk_bf16_f32 v50, v247, v248
    v_cvt_pk_bf16_f32 v51, v249, v250
    s_mov_b32 s59, 0
    s_waitcnt vmcnt(0)
    v_readfirstlane_b32 s40, v8
    s_nop 0
    s_cmp_lt_u32 s40, 32
    s_cbranch_scc1 L_gat_10_slow
L_gat_10:
    s_add_u32 s59, s59, 1
    s_cmp_lt_u32 s59, 40000
    s_cselect_b64 s[46:47], -1, 0
    buffer_load_dwordx4 v[218:221], v14, s[32:35], 0 offen offset:0 sc1
    buffer_load_dwordx4 v[242:245], v14, s[32:35], 0 offen offset:1024 sc1
    s_add_u32 s58, s63, 0
    s_and_b32 s58, s58, 0x3fff
    buffer_load_dwordx4 v[70:73], v12, s[32:35], s58 offen offset:0 sc1
    buffer_load_dwordx4 v[74:77], v12, s[32:35], s58 offen offset:1024 sc1
    s_add_u32 s58, s63, 2048
    s_and_b32 s58, s58, 0x3fff
    buffer_load_dwordx4 v[78:81], v12, s[32:35], s58 offen offset:0 sc1
    buffer_load_dwordx4 v[82:85], v12, s[32:35], s58 offen offset:1024 sc1
    s_add_u32 s58, s63, 4096
    s_and_b32 s58, s58, 0x3fff
    buffer_load_dwordx4 v[86:89], v12, s[32:35], s58 offen offset:0 sc1
    buffer_load_dwordx4 v[90:93], v12, s[32:35], s58 offen offset:1024 sc1
    s_add_u32 s58, s63, 6144
    s_and_b32 s58, s58, 0x3fff
    buffer_load_dwordx4 v[94:97], v12, s[32:35], s58 offen offset:0 sc1
    buffer_load_dwordx4 v[98:101], v12, s[32:35], s58 offen offset:1024 sc1
    s_add_u32 s58, s63, 8192
    s_and_b32 s58, s58, 0x3fff
    buffer_load_dwordx4 v[102:105], v12, s[32:35], s58 offen offset:0 sc1
    buffer_load_dwordx4 v[106:109], v12, s[32:35], s58 offen offset:1024 sc1
    s_add_u32 s58, s63, 10240
    s_and_b32 s58, s58, 0x3fff
    buffer_load_dwordx4 v[110:113], v12, s[32:35], s58 offen offset:0 sc1
    buffer_load_dwordx4 v[114:117], v12, s[32:35], s58 offen offset:1024 sc1
    s_add_u32 s58, s63, 12288
    s_and_b32 s58, s58, 0x3fff
    buffer_load_dwordx4 v[118:121], v12, s[32:35], s58 offen offset:0 sc1
    buffer_load_dwordx4 v[122:125], v12, s[32:35], s58 offen offset:1024 sc1
    s_add_u32 s58, s63, 14336
    s_and_b32 s58, s58, 0x3fff
    buffer_load_dwordx4 v[126:129], v12, s[32:35], s58 offen offset:0 sc1
    buffer_load_dwordx4 v[130:133], v12, s[32:35], s58 offen offset:1024 sc1
    v_mul_f32 v247, s61, v202
    v_mul_f32 v248, s61, v203
    v_mul_f32 v249, s61, v204
    v_mul_f32 v250, s61, v205
    v_exp_f32_e64 v247, v247 clamp
    v_max_f32 v251, s60, v202
    v_exp_f32_e64 v248, v248 clamp
    v_max_f32 v252, s60, v203
    v_exp_f32_e64 v249, v249 clamp
    v_max_f32 v253, s60, v204
    v_exp_f32_e64 v250, v250 clamp
    v_max_f32 v254, s60, v205
    v_add_f32 v247, v247, v251
    v_add_f32 v248, v248, v252
    v_add_f32 v249, v249, v253
    v_add_f32 v250, v250, v254
    v_cvt_pk_bf16_f32 v52, v247, v248
    v_cvt_pk_bf16_f32 v53, v249, v250
    v_mul_f32 v247, s61, v222
    v_mul_f32 v248, s61, v223
    v_mul_f32 v249, s61, v224
    v_mul_f32 v250, s61, v225
    v_exp_f32_e64 v247, v247 clamp
    v_max_f32 v251, s60, v222
    v_exp_f32_e64 v248, v248 clamp
    v_max_f32 v252, s60, v223
    v_exp_f32_e64 v249, v249 clamp
    v_max_f32 v253, s60, v224
    v_exp_f32_e64 v250, v250 clamp
    v_max_f32 v254, s60, v225
    v_add_f32 v247, v247, v251
    v_add_f32 v248, v248, v252
    v_add_f32 v249, v249, v253
    v_add_f32 v250, v250, v254
    v_cvt_pk_bf16_f32 v54, v247, v248
    v_cvt_pk_bf16_f32 v55, v249, v250
    v_mul_f32 v247, s61, v226
    v_mul_f32 v248, s61, v227
    v_mul_f32 v249, s61, v228
    v_mul_f32 v250, s61, v229
    v_exp_f32_e64 v247, v247 clamp
    v_max_f32 v251, s60, v226
    v_exp_f32_e64 v248, v248 clamp
    v_max_f32 v252, s60, v227
    v_exp_f32_e64 v249, v249 clamp
    v_max_f32 v253, s60, v228
    v_exp_f32_e64 v250, v250 clamp
    v_max_f32 v254, s60, v229
    v_add_f32 v247, v247, v251
    v_add_f32 v248, v248, v252
    v_add_f32 v249, v249, v253
    v_add_f32 v250, v250, v254
    v_cvt_pk_bf16_f32 v56, v247, v248
    v_cvt_pk_bf16_f32 v57, v249, v250
    s_waitcnt vmcnt(17)
    v_lshlrev_b32 v158, 16, v218
    v_and_b32 v159, 0xffff0000, v218
    s_waitcnt vmcnt(16)
    v_lshlrev_b32 v247, 16, v242
    v_and_b32 v248, 0xffff0000, v242
    v_add_f32 v158, v158, v247
    v_add_f32 v159, v159, v248
    v_lshlrev_b32 v160, 16, v219
    v_and_b32 v161, 0xffff0000, v219
    v_lshlrev_b32 v247, 16, v243
    v_and_b32 v248, 0xffff0000, v243
    v_add_f32 v160, v160, v247
    v_add_f32 v161, v161, v248
    v_lshlrev_b32 v162, 16, v220
    v_and_b32 v163, 0xffff0000, v220
    v_lshlrev_b32 v247, 16, v244
    v_and_b32 v248, 0xffff0000, v244
    v_add_f32 v162, v162, v247
    v_add_f32 v163, v163, v248
    v_lshlrev_b32 v164, 16, v221
    v_and_b32 v165, 0xffff0000, v221
    v_lshlrev_b32 v247, 16, v245
    v_and_b32 v248, 0xffff0000, v245
    v_add_f32 v164, v164, v247
    v_add_f32 v165, v165, v248
    v_add_f32_dpp v158, v158, v158 row_ror:8 row_mask:0xf bank_mask:0xf
    v_add_f32_dpp v159, v159, v159 row_ror:8 row_mask:0xf bank_mask:0xf
    v_add_f32_dpp v160, v160, v160 row_ror:8 row_mask:0xf bank_mask:0xf
    v_add_f32_dpp v161, v161, v161 row_ror:8 row_mask:0xf bank_mask:0xf
    v_add_f32_dpp v162, v162, v162 row_ror:8 row_mask:0xf bank_mask:0xf
    v_add_f32_dpp v163, v163, v163 row_ror:8 row_mask:0xf bank_mask:0xf
    v_add_f32_dpp v164, v164, v164 row_ror:8 row_mask:0xf bank_mask:0xf
    v_add_f32_dpp v165, v165, v165 row_ror:8 row_mask:0xf bank_mask:0xf
    v_add_f32_dpp v158, v158, v158 row_ror:4 row_mask:0xf bank_mask:0xf
    v_add_f32_dpp v159, v159, v159 row_ror:4 row_mask:0xf bank_mask:0xf
    v_add_f32_dpp v160, v160, v160 row_ror:4 row_mask:0xf bank_mask:0xf
    v_add_f32_dpp v161, v161, v161 row_ror:4 row_mask:0xf bank_mask:0xf
    v_add_f32_dpp v162, v162, v162 row_ror:4 row_mask:0xf bank_mask:0xf
    v_add_f32_dpp v163, v163, v163 row_ror:4 row_mask:0xf bank_mask:0xf
    v_add_f32_dpp v164, v164, v164 row_ror:4 row_mask:0xf bank_mask:0xf
    v_add_f32_dpp v165, v165, v165 row_ror:4 row_mask:0xf bank_mask:0xf
    v_add_f32_dpp v158, v158, v158 row_ror:2 row_mask:0xf bank_mask:0xf
    v_add_f32_dpp v159, v159, v159 row_ror:2 row_mask:0xf bank_mask:0xf
    v_add_f32_dpp v160, v160, v160 row_ror:2 row_mask:0xf bank_mask:0xf
    v_add_f32_dpp v161, v161, v161 row_ror:2 row_mask:0xf bank_mask:0xf
    v_add_f32_dpp v162, v162, v162 row_ror:2 row_mask:0xf bank_mask:0xf
    v_add_f32_dpp v163, v163, v163 row_ror:2 row_mask:0xf bank_mask:0xf
    v_add_f32_dpp v164, v164, v164 row_ror:2 row_mask:0xf bank_mask:0xf
    v_add_f32_dpp v165, v165, v165 row_ror:2 row_mask:0xf bank_mask:0xf
    v_add_f32_dpp v158, v158, v158 row_ror:1 row_mask:0xf bank_mask:0xf
    v_add_f32_dpp v159, v159, v159 row_ror:1 row_mask:0xf bank_mask:0xf
    v_add_f32_dpp v160, v160, v160 row_ror:1 row_mask:0xf bank_mask:0xf
    v_add_f32_dpp v161, v161, v161 row_ror:1 row_mask:0xf bank_mask:0xf
    v_add_f32_dpp v162, v162, v162 row_ror:1 row_mask:0xf bank_mask:0xf
    v_add_f32_dpp v163, v163, v163 row_ror:1 row_mask:0xf bank_mask:0xf
    v_add_f32_dpp v164, v164, v164 row_ror:1 row_mask:0xf bank_mask:0xf
    v_add_f32_dpp v165, v165, v165 row_ror:1 row_mask:0xf bank_mask:0xf
    v_cvt_pk_bf16_f32 v182, v158, v159
    v_cvt_pk_bf16_f32 v183, v160, v161
    v_cvt_pk_bf16_f32 v184, v162, v163
    v_cvt_pk_bf16_f32 v185, v164, v165
    s_nop 1
    v_mfma_f32_16x16x32_bf16 v[134:137], v[182:185], v[42:45], 0
    v_mfma_f32_16x16x32_bf16 v[138:141], v[182:185], v[46:49], 0
    v_mfma_f32_16x16x32_bf16 v[142:145], v[182:185], v[50:53], 0
    v_mfma_f32_16x16x32_bf16 v[146:149], v[182:185], v[54:57], 0
    s_waitcnt vmcnt(15)
    v_mfma_f32_16x16x32_bf16 v[186:189], v[34:37], v[70:73], 0
    v_mfma_f32_16x16x32_bf16 v[206:209], v[32:35], v[70:73], 0
    s_waitcnt vmcnt(14)
    v_mfma_f32_16x16x32_bf16 v[186:189], v[34:37], v[74:77], v[186:189]
    v_mfma_f32_16x16x32_bf16 v[206:209], v[32:35], v[74:77], v[206:209]
    s_waitcnt vmcnt(13)
    v_mfma_f32_16x16x32_bf16 v[186:189], v[34:37], v[78:81], v[186:189]
    v_mfma_f32_16x16x32_bf16 v[206:209], v[32:35], v[78:81], v[206:209]
    s_waitcnt vmcnt(12)
    v_mfma_f32_16x16x32_bf16 v[186:189], v[34:37], v[82:85], v[186:189]
    v_mfma_f32_16x16x32_bf16 v[206:209], v[32:35], v[82:85], v[206:209]
    s_waitcnt vmcnt(11)
    v_mfma_f32_16x16x32_bf16 v[186:189], v[34:37], v[86:89], v[186:189]
    v_mfma_f32_16x16x32_bf16 v[206:209], v[32:35], v[86:89], v[206:209]
    v_add_f32 v134, s60, v134
    v_add_f32 v138, s60, v138
    v_add_f32 v142, s60, v142
    v_add_f32 v146, s60, v146
    s_waitcnt vmcnt(10)
    v_mfma_f32_16x16x32_bf16 v[186:189], v[34:37], v[90:93], v[186:189]
    v_mfma_f32_16x16x32_bf16 v[206:209], v[32:35], v[90:93], v[206:209]
    v_rcp_f32 v135, v134
    v_rcp_f32 v139, v138
    v_rcp_f32 v143, v142
    v_rcp_f32 v147, v146
    s_waitcnt vmcnt(9)
    v_mfma_f32_16x16x32_bf16 v[186:189], v[34:37], v[94:97], v[186:189]
    v_mfma_f32_16x16x32_bf16 v[206:209], v[32:35], v[94:97], v[206:209]
    s_waitcnt vmcnt(8)
    v_mfma_f32_16x16x32_bf16 v[186:189], v[34:37], v[98:101], v[186:189]
    v_mfma_f32_16x16x32_bf16 v[206:209], v[32:35], v[98:101], v[206:209]
    s_waitcnt vmcnt(7)
    v_mfma_f32_16x16x32_bf16 v[186:189], v[34:37], v[102:105], v[186:189]
    v_mfma_f32_16x16x32_bf16 v[206:209], v[32:35], v[102:105], v[206:209]
    s_waitcnt vmcnt(6)
    v_mfma_f32_16x16x32_bf16 v[186:189], v[34:37], v[106:109], v[186:189]
    v_mfma_f32_16x16x32_bf16 v[206:209], v[32:35], v[106:109], v[206:209]
    s_waitcnt vmcnt(5)
    v_mfma_f32_16x16x32_bf16 v[186:189], v[34:37], v[110:113], v[186:189]
    v_mfma_f32_16x16x32_bf16 v[206:209], v[32:35], v[110:113], v[206:209]
    s_waitcnt vmcnt(4)
    v_mfma_f32_16x16x32_bf16 v[186:189], v[34:37], v[114:117], v[186:189]
    v_mfma_f32_16x16x32_bf16 v[206:209], v[32:35], v[114:117], v[206:209]
    s_waitcnt vmcnt(3)
    v_mfma_f32_16x16x32_bf16 v[186:189], v[34:37], v[118:121], v[186:189]
    v_mfma_f32_16x16x32_bf16 v[206:209], v[32:35], v[118:121], v[206:209]
    s_waitcnt vmcnt(2)
    v_mfma_f32_16x16x32_bf16 v[186:189], v[34:37], v[122:125], v[186:189]
    v_mfma_f32_16x16x32_bf16 v[206:209], v[32:35], v[122:125], v[206:209]
    s_waitcnt vmcnt(1)
    v_mfma_f32_16x16x32_bf16 v[186:189], v[34:37], v[126:129], v[186:189]
    v_mfma_f32_16x16x32_bf16 v[206:209], v[32:35], v[126:129], v[206:209]
    s_waitcnt vmcnt(0)
    v_mfma_f32_16x16x32_bf16 v[186:189], v[34:37], v[130:133], v[186:189]
    v_mfma_f32_16x16x32_bf16 v[206:209], v[32:35], v[130:133], v[206:209]
    s_nop 6
    v_cmp_u_f32 vcc, v186, v134
    v_cvt_pk_bf16_f32 v234, v186, v187
    v_cvt_pk_bf16_f32 v235, v188, v189
    v_cvt_pk_bf16_f32 v236, v206, v207
    v_cvt_pk_bf16_f32 v237, v208, v209
    s_and_b64 vcc, vcc, s[46:47]
    s_cbranch_scc1 L_gat_10
    ds_write_b128 v17, v[234:237]
    ds_write_b32 v19, v3
    s_mov_b32 s43, 0
L_pw_12:
    ds_read_b32 v1, v20
    ds_read_b128 v[210:213], v18
    ds_read_b128 v[230:233], v18 offset:2048
    s_add_u32 s43, s43, 1
    s_cmp_gt_u32 s43, 400000
    s_waitcnt lgkmcnt(0)
    s_cbranch_scc1 L_pwd_13
    v_cmp_ne_u32 vcc, 1, v1
    s_cbranch_vccnz L_pw_12
L_pwd_13:
    v_mfma_f32_16x16x32_bf16 v[70:73], v[210:213], v[42:45], 0
    v_mfma_f32_16x16x32_bf16 v[74:77], v[230:233], v[42:45], 0
    v_mfma_f32_16x16x32_bf16 v[78:81], v[210:213], v[46:49], 0
    v_mfma_f32_16x16x32_bf16 v[82:85], v[230:233], v[46:49], 0
    v_mfma_f32_16x16x32_bf16 v[86:89], v[210:213], v[50:53], 0
    v_mfma_f32_16x16x32_bf16 v[90:93], v[230:233], v[50:53], 0
    v_mfma_f32_16x16x32_bf16 v[94:97], v[210:213], v[54:57], 0
    v_mfma_f32_16x16x32_bf16 v[98:101], v[230:233], v[54:57], 0
    s_nop 0
    v_mul_f32 v70, v70, v135
    v_mul_f32 v71, v71, v135
    v_mul_f32 v72, v72, v135
    v_mul_f32 v73, v73, v135
    v_mul_f32 v74, v74, v135
    v_mul_f32 v75, v75, v135
    v_mul_f32 v76, v76, v135
    v_mul_f32 v77, v77, v135
    v_cvt_pk_bf16_f32 v42, v70, v71
    v_cvt_pk_bf16_f32 v43, v72, v73
    v_cvt_pk_bf16_f32 v44, v74, v75
    v_cvt_pk_bf16_f32 v45, v76, v77
    s_mov_b32 s58, 0
    buffer_store_dwordx4 v[42:45], v21, s[32:35], s58 offen sc1
    v_mul_f32 v78, v78, v139
    v_mul_f32 v79, v79, v139
    v_mul_f32 v80, v80, v139
    v_mul_f32 v81, v81, v139
    v_mul_f32 v82, v82, v139
    v_mul_f32 v83, v83, v139
    v_mul_f32 v84, v84, v139
    v_mul_f32 v85, v85, v139
    v_cvt_pk_bf16_f32 v46, v78, v79
    v_cvt_pk_bf16_f32 v47, v80, v81
    v_cvt_pk_bf16_f32 v48, v82, v83
    v_cvt_pk_bf16_f32 v49, v84, v85
    s_mov_b32 s58, 32768
    buffer_store_dwordx4 v[46:49], v21, s[32:35], s58 offen sc1
    v_mul_f32 v86, v86, v143
    v_mul_f32 v87, v87, v143
    v_mul_f32 v88, v88, v143
    v_mul_f32 v89, v89, v143
    v_mul_f32 v90, v90, v143
    v_mul_f32 v91, v91, v143
    v_mul_f32 v92, v92, v143
    v_mul_f32 v93, v93, v143
    v_cvt_pk_bf16_f32 v50, v86, v87
    v_cvt_pk_bf16_f32 v51, v88, v89
    v_cvt_pk_bf16_f32 v52, v90, v91
    v_cvt_pk_bf16_f32 v53, v92, v93
    s_mov_b32 s58, 65536
    buffer_store_dwordx4 v[50:53], v21, s[32:35], s58 offen sc1
    v_mul_f32 v94, v94, v147
    v_mul_f32 v95, v95, v147
    v_mul_f32 v96, v96, v147
    v_mul_f32 v97, v97, v147
    v_mul_f32 v98, v98, v147
    v_mul_f32 v99, v99, v147
    v_mul_f32 v100, v100, v147
    v_mul_f32 v101, v101, v147
    v_cvt_pk_bf16_f32 v54, v94, v95
    v_cvt_pk_bf16_f32 v55, v96, v97
    v_cvt_pk_bf16_f32 v56, v98, v99
    v_cvt_pk_bf16_f32 v57, v100, v101
    s_mov_b32 s58, 98304
    buffer_store_dwordx4 v[54:57], v21, s[32:35], s58 offen sc1
    ds_write_b32 v15, v3 offset:4608
    v_add_f32_dpp v58, v58, v58 row_shr:1 row_mask:0xf bank_mask:0xf
    s_nop 1
    v_add_f32_dpp v58, v58, v58 row_shr:2 row_mask:0xf bank_mask:0xf
    s_nop 1
    v_add_f32_dpp v58, v58, v58 row_shr:4 row_mask:0xf bank_mask:0xf
    s_nop 1
    v_add_f32_dpp v58, v58, v58 row_shr:8 row_mask:0xf bank_mask:0xf
    s_nop 1
    v_add_f32_dpp v58, v58, v58 row_bcast:15 row_mask:0xa bank_mask:0xf
    v_cvt_pk_bf16_f32 v58, v58, v58
    v_lshlrev_b32 v58, 16, v58
    v_mul_f32 v58, 3216550459, v58
    v_exp_f32 v58, v58
    s_nop 0
    v_add_f32 v58, 1.0, v58
    v_rcp_f32 v58, v58
    s_nop 0
    v_cvt_pk_bf16_f32 v58, v58, v58
    v_lshlrev_b32 v58, 16, v58
    s_mov_b32 s43, 0
L_lf_14:
    ds_read_b128 v[64:67], v24
    s_add_u32 s43, s43, 1
    s_cmp_gt_u32 s43, 400000
    s_waitcnt lgkmcnt(0)
    s_cbranch_scc1 L_lfd_15
    v_min_u32 v64, v64, v65
    v_min3_u32 v64, v64, v66, v67
    v_cmp_gt_u32 vcc, 1, v64
    s_cbranch_vccnz L_lf_14
L_lfd_15:
    ds_read_b64_tr_b16 v[68:69], v26 offset:0
    ds_read_b64_tr_b16 v[70:71], v26 offset:2048
    ds_read_b64_tr_b16 v[72:73], v27 offset:0
    ds_read_b64_tr_b16 v[74:75], v27 offset:2048
    ds_read_b64_tr_b16 v[76:77], v28 offset:0
    ds_read_b64_tr_b16 v[78:79], v28 offset:2048
    ds_read_b64_tr_b16 v[80:81], v29 offset:0
    ds_read_b64_tr_b16 v[82:83], v29 offset:2048
    s_waitcnt vmcnt(0)
    s_mov_b64 exec, 0xffff
    buffer_atomic_add v3, v7, s[32:35], 0 offen sc1
    s_mov_b64 exec, s[68:69]
    buffer_store_dword v58, v59, s[32:35], 0 offen sc1
    s_mov_b64 exec, 1
    s_mov_b32 s43, 0
    v_mov_b32 v8, 0
    buffer_atomic_add v8, v5, s[32:35], 0 offen sc0 sc1
L_pc_16:
    s_sleep 2
    v_mov_b32 v9, 0
    buffer_atomic_add v9, v5, s[32:35], 0 offen sc0 sc1
    s_waitcnt vmcnt(1)
    v_cmp_gt_u32 vcc, 32, v8
    s_cbranch_vccz L_c2d
    s_sleep 2
    v_mov_b32 v8, 0
    buffer_atomic_add v8, v5, s[32:35], 0 offen sc0 sc1
    s_add_u32 s43, s43, 1
    s_waitcnt vmcnt(1)
    v_cmp_gt_u32 vcc, 32, v9
    s_cbranch_vccz L_c2d
    s_cmp_lt_u32 s43, 40000
    s_cbranch_scc1 L_pc_16
L_c2d:
    s_mov_b64 exec, -1
    s_add_u32 s70, s44, 0
    s_and_b32 s70, s70, 0x7fff
    buffer_load_dwordx4 v[164:167], v22, s[32:35], s70 offen offset:0 sc1
    s_add_u32 s71, s70, 32768
    buffer_load_dwordx4 v[168:171], v22, s[32:35], s71 offen offset:0 sc1
    buffer_load_dwordx4 v[172:175], v22, s[32:35], s70 offen offset:1024 sc1
    buffer_load_dwordx4 v[176:179], v22, s[32:35], s71 offen offset:1024 sc1
    buffer_load_dwordx4 v[180:183], v22, s[32:35], s70 offen offset:2048 sc1
    buffer_load_dwordx4 v[184:187], v22, s[32:35], s71 offen offset:2048 sc1
    buffer_load_dwordx4 v[188:191], v22, s[32:35], s70 offen offset:3072 sc1
    buffer_load_dwordx4 v[192:195], v22, s[32:35], s71 offen offset:3072 sc1
    s_waitcnt vmcnt(7) lgkmcnt(6)
    v_mfma_f32_16x16x32_bf16 v[100:103], v[68:71], v[164:167], 0
    ds_read_b64_tr_b16 v[84:85], v26 offset:4096
    s_waitcnt lgkmcnt(5)
    v_mfma_f32_16x16x32_bf16 v[104:107], v[72:75], v[164:167], 0
    ds_read_b64_tr_b16 v[86:87], v26 offset:6144
    s_waitcnt lgkmcnt(4)
    v_mfma_f32_16x16x32_bf16 v[108:111], v[76:79], v[164:167], 0
    ds_read_b64_tr_b16 v[88:89], v27 offset:4096
    s_waitcnt lgkmcnt(3)
    v_mfma_f32_16x16x32_bf16 v[112:115], v[80:83], v[164:167], 0
    ds_read_b64_tr_b16 v[90:91], v27 offset:6144
    s_add_u32 s70, s44, 4096
    s_and_b32 s70, s70, 0x7fff
    buffer_load_dwordx4 v[164:167], v22, s[32:35], s70 offen offset:0 sc1
    s_waitcnt vmcnt(7)
    v_mfma_f32_16x16x32_bf16 v[116:119], v[68:71], v[168:171], 0
    ds_read_b64_tr_b16 v[92:93], v28 offset:4096
    v_mfma_f32_16x16x32_bf16 v[120:123], v[72:75], v[168:171], 0
    ds_read_b64_tr_b16 v[94:95], v28 offset:6144
    v_mfma_f32_16x16x32_bf16 v[124:127], v[76:79], v[168:171], 0
    ds_read_b64_tr_b16 v[96:97], v29 offset:4096
    v_mfma_f32_16x16x32_bf16 v[128:131], v[80:83], v[168:171], 0
    ds_read_b64_tr_b16 v[98:99], v29 offset:6144
    s_add_u32 s71, s70, 32768
    buffer_load_dwordx4 v[168:171], v22, s[32:35], s71 offen offset:0 sc1
    s_waitcnt vmcnt(7) lgkmcnt(6)
    v_mfma_f32_16x16x32_bf16 v[100:103], v[84:87], v[172:175], v[100:103]
    ds_read_b64_tr_b16 v[68:69], v26 offset:8192
    s_waitcnt lgkmcnt(5)
    v_mfma_f32_16x16x32_bf16 v[104:107], v[88:91], v[172:175], v[104:107]
    ds_read_b64_tr_b16 v[70:71], v26 offset:10240
    s_waitcnt lgkmcnt(4)
    v_mfma_f32_16x16x32_bf16 v[108:111], v[92:95], v[172:175], v[108:111]
    ds_read_b64_tr_b16 v[72:73], v27 offset:8192
    s_waitcnt lgkmcnt(3)
    v_mfma_f32_16x16x32_bf16 v[112:115], v[96:99], v[172:175], v[112:115]
    ds_read_b64_tr_b16 v[74:75], v27 offset:10240
    buffer_load_dwordx4 v[172:175], v22, s[32:35], s70 offen offset:1024 sc1
    s_waitcnt vmcnt(7)
    v_mfma_f32_16x16x32_bf16 v[116:119], v[84:87], v[176:179], v[116:119]
    ds_read_b64_tr_b16 v[76:77], v28 offset:8192
    v_mfma_f32_16x16x32_bf16 v[120:123], v[88:91], v[176:179], v[120:123]
    ds_read_b64_tr_b16 v[78:79], v28 offset:10240
    v_mfma_f32_16x16x32_bf16 v[124:127], v[92:95], v[176:179], v[124:127]
    ds_read_b64_tr_b16 v[80:81], v29 offset:8192
    v_mfma_f32_16x16x32_bf16 v[128:131], v[96:99], v[176:179], v[128:131]
    ds_read_b64_tr_b16 v[82:83], v29 offset:10240
    buffer_load_dwordx4 v[176:179], v22, s[32:35], s71 offen offset:1024 sc1
    s_waitcnt vmcnt(7) lgkmcnt(6)
    v_mfma_f32_16x16x32_bf16 v[100:103], v[68:71], v[180:183], v[100:103]
    ds_read_b64_tr_b16 v[84:85], v26 offset:12288
    s_waitcnt lgkmcnt(5)
    v_mfma_f32_16x16x32_bf16 v[104:107], v[72:75], v[180:183], v[104:107]
    ds_read_b64_tr_b16 v[86:87], v26 offset:14336
    s_waitcnt lgkmcnt(4)
    v_mfma_f32_16x16x32_bf16 v[108:111], v[76:79], v[180:183], v[108:111]
    ds_read_b64_tr_b16 v[88:89], v27 offset:12288
    s_waitcnt lgkmcnt(3)
    v_mfma_f32_16x16x32_bf16 v[112:115], v[80:83], v[180:183], v[112:115]
    ds_read_b64_tr_b16 v[90:91], v27 offset:14336
    buffer_load_dwordx4 v[180:183], v22, s[32:35], s70 offen offset:2048 sc1
    s_waitcnt vmcnt(7)
    v_mfma_f32_16x16x32_bf16 v[116:119], v[68:71], v[184:187], v[116:119]
    ds_read_b64_tr_b16 v[92:93], v28 offset:12288
    v_mfma_f32_16x16x32_bf16 v[120:123], v[72:75], v[184:187], v[120:123]
    ds_read_b64_tr_b16 v[94:95], v28 offset:14336
    v_mfma_f32_16x16x32_bf16 v[124:127], v[76:79], v[184:187], v[124:127]
    ds_read_b64_tr_b16 v[96:97], v29 offset:12288
    v_mfma_f32_16x16x32_bf16 v[128:131], v[80:83], v[184:187], v[128:131]
    ds_read_b64_tr_b16 v[98:99], v29 offset:14336
    buffer_load_dwordx4 v[184:187], v22, s[32:35], s71 offen offset:2048 sc1
    s_waitcnt vmcnt(7) lgkmcnt(6)
    v_mfma_f32_16x16x32_bf16 v[100:103], v[84:87], v[188:191], v[100:103]
    ds_read_b64_tr_b16 v[68:69], v26 offset:16384
    s_waitcnt lgkmcnt(5)
    v_mfma_f32_16x16x32_bf16 v[104:107], v[88:91], v[188:191], v[104:107]
    ds_read_b64_tr_b16 v[70:71], v26 offset:18432
    s_waitcnt lgkmcnt(4)
    v_mfma_f32_16x16x32_bf16 v[108:111], v[92:95], v[188:191], v[108:111]
    ds_read_b64_tr_b16 v[72:73], v27 offset:16384
    s_waitcnt lgkmcnt(3)
    v_mfma_f32_16x16x32_bf16 v[112:115], v[96:99], v[188:191], v[112:115]
    ds_read_b64_tr_b16 v[74:75], v27 offset:18432
    buffer_load_dwordx4 v[188:191], v22, s[32:35], s70 offen offset:3072 sc1
    s_waitcnt vmcnt(7)
    v_mfma_f32_16x16x32_bf16 v[116:119], v[84:87], v[192:195], v[116:119]
    ds_read_b64_tr_b16 v[76:77], v28 offset:16384
    v_mfma_f32_16x16x32_bf16 v[120:123], v[88:91], v[192:195], v[120:123]
    ds_read_b64_tr_b16 v[78:79], v28 offset:18432
    v_mfma_f32_16x16x32_bf16 v[124:127], v[92:95], v[192:195], v[124:127]
    ds_read_b64_tr_b16 v[80:81], v29 offset:16384
    v_mfma_f32_16x16x32_bf16 v[128:131], v[96:99], v[192:195], v[128:131]
    ds_read_b64_tr_b16 v[82:83], v29 offset:18432
    buffer_load_dwordx4 v[192:195], v22, s[32:35], s71 offen offset:3072 sc1
    s_waitcnt vmcnt(7) lgkmcnt(6)
    v_mfma_f32_16x16x32_bf16 v[100:103], v[68:71], v[164:167], v[100:103]
    ds_read_b64_tr_b16 v[84:85], v26 offset:20480
    s_waitcnt lgkmcnt(5)
    v_mfma_f32_16x16x32_bf16 v[104:107], v[72:75], v[164:167], v[104:107]
    ds_read_b64_tr_b16 v[86:87], v26 offset:22528
    s_waitcnt lgkmcnt(4)
    v_mfma_f32_16x16x32_bf16 v[108:111], v[76:79], v[164:167], v[108:111]
    ds_read_b64_tr_b16 v[88:89], v27 offset:20480
    s_waitcnt lgkmcnt(3)
    v_mfma_f32_16x16x32_bf16 v[112:115], v[80:83], v[164:167], v[112:115]
    ds_read_b64_tr_b16 v[90:91], v27 offset:22528
    s_add_u32 s70, s44, 8192
    s_and_b32 s70, s70, 0x7fff
    buffer_load_dwordx4 v[164:167], v22, s[32:35], s70 offen offset:0 sc1
    s_waitcnt vmcnt(7)
    v_mfma_f32_16x16x32_bf16 v[116:119], v[68:71], v[168:171], v[116:119]
    ds_read_b64_tr_b16 v[92:93], v28 offset:20480
    v_mfma_f32_16x16x32_bf16 v[120:123], v[72:75], v[168:171], v[120:123]
    ds_read_b64_tr_b16 v[94:95], v28 offset:22528
    v_mfma_f32_16x16x32_bf16 v[124:127], v[76:79], v[168:171], v[124:127]
    ds_read_b64_tr_b16 v[96:97], v29 offset:20480
    v_mfma_f32_16x16x32_bf16 v[128:131], v[80:83], v[168:171], v[128:131]
    ds_read_b64_tr_b16 v[98:99], v29 offset:22528
    s_add_u32 s71, s70, 32768
    buffer_load_dwordx4 v[168:171], v22, s[32:35], s71 offen offset:0 sc1
    s_waitcnt vmcnt(7) lgkmcnt(6)
    v_mfma_f32_16x16x32_bf16 v[100:103], v[84:87], v[172:175], v[100:103]
    ds_read_b64_tr_b16 v[68:69], v26 offset:24576
    s_waitcnt lgkmcnt(5)
    v_mfma_f32_16x16x32_bf16 v[104:107], v[88:91], v[172:175], v[104:107]
    ds_read_b64_tr_b16 v[70:71], v26 offset:26624
    s_waitcnt lgkmcnt(4)
    v_mfma_f32_16x16x32_bf16 v[108:111], v[92:95], v[172:175], v[108:111]
    ds_read_b64_tr_b16 v[72:73], v27 offset:24576
    s_waitcnt lgkmcnt(3)
    v_mfma_f32_16x16x32_bf16 v[112:115], v[96:99], v[172:175], v[112:115]
    ds_read_b64_tr_b16 v[74:75], v27 offset:26624
    buffer_load_dwordx4 v[172:175], v22, s[32:35], s70 offen offset:1024 sc1
    s_waitcnt vmcnt(7)
    v_mfma_f32_16x16x32_bf16 v[116:119], v[84:87], v[176:179], v[116:119]
    ds_read_b64_tr_b16 v[76:77], v28 offset:24576
    v_mfma_f32_16x16x32_bf16 v[120:123], v[88:91], v[176:179], v[120:123]
    ds_read_b64_tr_b16 v[78:79], v28 offset:26624
    v_mfma_f32_16x16x32_bf16 v[124:127], v[92:95], v[176:179], v[124:127]
    ds_read_b64_tr_b16 v[80:81], v29 offset:24576
    v_mfma_f32_16x16x32_bf16 v[128:131], v[96:99], v[176:179], v[128:131]
    ds_read_b64_tr_b16 v[82:83], v29 offset:26624
    buffer_load_dwordx4 v[176:179], v22, s[32:35], s71 offen offset:1024 sc1
    s_waitcnt vmcnt(7) lgkmcnt(6)
    v_mfma_f32_16x16x32_bf16 v[100:103], v[68:71], v[180:183], v[100:103]
    ds_read_b64_tr_b16 v[84:85], v26 offset:28672
    s_waitcnt lgkmcnt(5)
    v_mfma_f32_16x16x32_bf16 v[104:107], v[72:75], v[180:183], v[104:107]
    ds_read_b64_tr_b16 v[86:87], v26 offset:30720
    s_waitcnt lgkmcnt(4)
    v_mfma_f32_16x16x32_bf16 v[108:111], v[76:79], v[180:183], v[108:111]
    ds_read_b64_tr_b16 v[88:89], v27 offset:28672
    s_waitcnt lgkmcnt(3)
    v_mfma_f32_16x16x32_bf16 v[112:115], v[80:83], v[180:183], v[112:115]
    ds_read_b64_tr_b16 v[90:91], v27 offset:30720
    buffer_load_dwordx4 v[180:183], v22, s[32:35], s70 offen offset:2048 sc1
    s_waitcnt vmcnt(7)
    v_mfma_f32_16x16x32_bf16 v[116:119], v[68:71], v[184:187], v[116:119]
    ds_read_b64_tr_b16 v[92:93], v28 offset:28672
    v_mfma_f32_16x16x32_bf16 v[120:123], v[72:75], v[184:187], v[120:123]
    ds_read_b64_tr_b16 v[94:95], v28 offset:30720
    v_mfma_f32_16x16x32_bf16 v[124:127], v[76:79], v[184:187], v[124:127]
    ds_read_b64_tr_b16 v[96:97], v29 offset:28672
    v_mfma_f32_16x16x32_bf16 v[128:131], v[80:83], v[184:187], v[128:131]
    ds_read_b64_tr_b16 v[98:99], v29 offset:30720
    buffer_load_dwordx4 v[184:187], v22, s[32:35], s71 offen offset:2048 sc1
    s_waitcnt vmcnt(7) lgkmcnt(6)
    v_mfma_f32_16x16x32_bf16 v[100:103], v[84:87], v[188:191], v[100:103]
    ds_read_b64_tr_b16 v[68:69], v26 offset:32768
    s_waitcnt lgkmcnt(5)
    v_mfma_f32_16x16x32_bf16 v[104:107], v[88:91], v[188:191], v[104:107]
    ds_read_b64_tr_b16 v[70:71], v26 offset:34816
    s_waitcnt lgkmcnt(4)
    v_mfma_f32_16x16x32_bf16 v[108:111], v[92:95], v[188:191], v[108:111]
    ds_read_b64_tr_b16 v[72:73], v27 offset:32768
    s_waitcnt lgkmcnt(3)
    v_mfma_f32_16x16x32_bf16 v[112:115], v[96:99], v[188:191], v[112:115]
    ds_read_b64_tr_b16 v[74:75], v27 offset:34816
    buffer_load_dwordx4 v[188:191], v22, s[32:35], s70 offen offset:3072 sc1
    s_waitcnt vmcnt(7)
    v_mfma_f32_16x16x32_bf16 v[116:119], v[84:87], v[192:195], v[116:119]
    ds_read_b64_tr_b16 v[76:77], v28 offset:32768
    v_mfma_f32_16x16x32_bf16 v[120:123], v[88:91], v[192:195], v[120:123]
    ds_read_b64_tr_b16 v[78:79], v28 offset:34816
    v_mfma_f32_16x16x32_bf16 v[124:127], v[92:95], v[192:195], v[124:127]
    ds_read_b64_tr_b16 v[80:81], v29 offset:32768
    v_mfma_f32_16x16x32_bf16 v[128:131], v[96:99], v[192:195], v[128:131]
    ds_read_b64_tr_b16 v[82:83], v29 offset:34816
    buffer_load_dwordx4 v[192:195], v22, s[32:35], s71 offen offset:3072 sc1
    s_waitcnt vmcnt(7) lgkmcnt(6)
    v_mfma_f32_16x16x32_bf16 v[100:103], v[68:71], v[164:167], v[100:103]
    ds_read_b64_tr_b16 v[84:85], v26 offset:36864
    s_waitcnt lgkmcnt(5)
    v_mfma_f32_16x16x32_bf16 v[104:107], v[72:75], v[164:167], v[104:107]
    ds_read_b64_tr_b16 v[86:87], v26 offset:38912
    s_waitcnt lgkmcnt(4)
    v_mfma_f32_16x16x32_bf16 v[108:111], v[76:79], v[164:167], v[108:111]
    ds_read_b64_tr_b16 v[88:89], v27 offset:36864
    s_waitcnt lgkmcnt(3)
    v_mfma_f32_16x16x32_bf16 v[112:115], v[80:83], v[164:167], v[112:115]
    ds_read_b64_tr_b16 v[90:91], v27 offset:38912
    s_add_u32 s70, s44, 12288
    s_and_b32 s70, s70, 0x7fff
    buffer_load_dwordx4 v[164:167], v22, s[32:35], s70 offen offset:0 sc1
    s_waitcnt vmcnt(7)
    v_mfma_f32_16x16x32_bf16 v[116:119], v[68:71], v[168:171], v[116:119]
    ds_read_b64_tr_b16 v[92:93], v28 offset:36864
    v_mfma_f32_16x16x32_bf16 v[120:123], v[72:75], v[168:171], v[120:123]
    ds_read_b64_tr_b16 v[94:95], v28 offset:38912
    v_mfma_f32_16x16x32_bf16 v[124:127], v[76:79], v[168:171], v[124:127]
    ds_read_b64_tr_b16 v[96:97], v29 offset:36864
    v_mfma_f32_16x16x32_bf16 v[128:131], v[80:83], v[168:171], v[128:131]
    ds_read_b64_tr_b16 v[98:99], v29 offset:38912
    s_add_u32 s71, s70, 32768
    buffer_load_dwordx4 v[168:171], v22, s[32:35], s71 offen offset:0 sc1
    s_waitcnt vmcnt(7) lgkmcnt(6)
    v_mfma_f32_16x16x32_bf16 v[100:103], v[84:87], v[172:175], v[100:103]
    ds_read_b64_tr_b16 v[68:69], v26 offset:40960
    s_waitcnt lgkmcnt(5)
    v_mfma_f32_16x16x32_bf16 v[104:107], v[88:91], v[172:175], v[104:107]
    ds_read_b64_tr_b16 v[70:71], v26 offset:43008
    s_waitcnt lgkmcnt(4)
    v_mfma_f32_16x16x32_bf16 v[108:111], v[92:95], v[172:175], v[108:111]
    ds_read_b64_tr_b16 v[72:73], v27 offset:40960
    s_waitcnt lgkmcnt(3)
    v_mfma_f32_16x16x32_bf16 v[112:115], v[96:99], v[172:175], v[112:115]
    ds_read_b64_tr_b16 v[74:75], v27 offset:43008
    buffer_load_dwordx4 v[172:175], v22, s[32:35], s70 offen offset:1024 sc1
    s_waitcnt vmcnt(7)
    v_mfma_f32_16x16x32_bf16 v[116:119], v[84:87], v[176:179], v[116:119]
    ds_read_b64_tr_b16 v[76:77], v28 offset:40960
    v_mfma_f32_16x16x32_bf16 v[120:123], v[88:91], v[176:179], v[120:123]
    ds_read_b64_tr_b16 v[78:79], v28 offset:43008
    v_mfma_f32_16x16x32_bf16 v[124:127], v[92:95], v[176:179], v[124:127]
    ds_read_b64_tr_b16 v[80:81], v29 offset:40960
    v_mfma_f32_16x16x32_bf16 v[128:131], v[96:99], v[176:179], v[128:131]
    ds_read_b64_tr_b16 v[82:83], v29 offset:43008
    buffer_load_dwordx4 v[176:179], v22, s[32:35], s71 offen offset:1024 sc1
    s_waitcnt vmcnt(7) lgkmcnt(6)
    v_mfma_f32_16x16x32_bf16 v[100:103], v[68:71], v[180:183], v[100:103]
    ds_read_b64_tr_b16 v[84:85], v26 offset:45056
    s_waitcnt lgkmcnt(5)
    v_mfma_f32_16x16x32_bf16 v[104:107], v[72:75], v[180:183], v[104:107]
    ds_read_b64_tr_b16 v[86:87], v26 offset:47104
    s_waitcnt lgkmcnt(4)
    v_mfma_f32_16x16x32_bf16 v[108:111], v[76:79], v[180:183], v[108:111]
    ds_read_b64_tr_b16 v[88:89], v27 offset:45056
    s_waitcnt lgkmcnt(3)
    v_mfma_f32_16x16x32_bf16 v[112:115], v[80:83], v[180:183], v[112:115]
    ds_read_b64_tr_b16 v[90:91], v27 offset:47104
    buffer_load_dwordx4 v[180:183], v22, s[32:35], s70 offen offset:2048 sc1
    s_waitcnt vmcnt(7)
    v_mfma_f32_16x16x32_bf16 v[116:119], v[68:71], v[184:187], v[116:119]
    ds_read_b64_tr_b16 v[92:93], v28 offset:45056
    v_mfma_f32_16x16x32_bf16 v[120:123], v[72:75], v[184:187], v[120:123]
    ds_read_b64_tr_b16 v[94:95], v28 offset:47104
    v_mfma_f32_16x16x32_bf16 v[124:127], v[76:79], v[184:187], v[124:127]
    ds_read_b64_tr_b16 v[96:97], v29 offset:45056
    v_mfma_f32_16x16x32_bf16 v[128:131], v[80:83], v[184:187], v[128:131]
    ds_read_b64_tr_b16 v[98:99], v29 offset:47104
    buffer_load_dwordx4 v[184:187], v22, s[32:35], s71 offen offset:2048 sc1
    s_waitcnt vmcnt(7) lgkmcnt(6)
    v_mfma_f32_16x16x32_bf16 v[100:103], v[84:87], v[188:191], v[100:103]
    ds_read_b64_tr_b16 v[68:69], v26 offset:49152
    s_waitcnt lgkmcnt(5)
    v_mfma_f32_16x16x32_bf16 v[104:107], v[88:91], v[188:191], v[104:107]
    ds_read_b64_tr_b16 v[70:71], v26 offset:51200
    s_waitcnt lgkmcnt(4)
    v_mfma_f32_16x16x32_bf16 v[108:111], v[92:95], v[188:191], v[108:111]
    ds_read_b64_tr_b16 v[72:73], v27 offset:49152
    s_waitcnt lgkmcnt(3)
    v_mfma_f32_16x16x32_bf16 v[112:115], v[96:99], v[188:191], v[112:115]
    ds_read_b64_tr_b16 v[74:75], v27 offset:51200
    buffer_load_dwordx4 v[188:191], v22, s[32:35], s70 offen offset:3072 sc1
    s_waitcnt vmcnt(7)
    v_mfma_f32_16x16x32_bf16 v[116:119], v[84:87], v[192:195], v[116:119]
    ds_read_b64_tr_b16 v[76:77], v28 offset:49152
    v_mfma_f32_16x16x32_bf16 v[120:123], v[88:91], v[192:195], v[120:123]
    ds_read_b64_tr_b16 v[78:79], v28 offset:51200
    v_mfma_f32_16x16x32_bf16 v[124:127], v[92:95], v[192:195], v[124:127]
    ds_read_b64_tr_b16 v[80:81], v29 offset:49152
    v_mfma_f32_16x16x32_bf16 v[128:131], v[96:99], v[192:195], v[128:131]
    ds_read_b64_tr_b16 v[82:83], v29 offset:51200
    buffer_load_dwordx4 v[192:195], v22, s[32:35], s71 offen offset:3072 sc1
    buffer_load_dword v60, v23, s[32:35], 0 offen sc1
    buffer_load_dword v61, v23, s[32:35], 0 offen offset:64 sc1
    s_waitcnt vmcnt(9) lgkmcnt(6)
    v_mfma_f32_16x16x32_bf16 v[100:103], v[68:71], v[164:167], v[100:103]
    ds_read_b64_tr_b16 v[84:85], v26 offset:53248
    s_waitcnt lgkmcnt(5)
    v_mfma_f32_16x16x32_bf16 v[104:107], v[72:75], v[164:167], v[104:107]
    ds_read_b64_tr_b16 v[86:87], v26 offset:55296
    s_waitcnt lgkmcnt(4)
    v_mfma_f32_16x16x32_bf16 v[108:111], v[76:79], v[164:167], v[108:111]
    ds_read_b64_tr_b16 v[88:89], v27 offset:53248
    s_waitcnt lgkmcnt(3)
    v_mfma_f32_16x16x32_bf16 v[112:115], v[80:83], v[164:167], v[112:115]
    ds_read_b64_tr_b16 v[90:91], v27 offset:55296
    s_add_u32 s70, s44, 16384
    s_and_b32 s70, s70, 0x7fff
    buffer_load_dwordx4 v[164:167], v22, s[32:35], s70 offen offset:0 sc1
    s_waitcnt vmcnt(9)
    v_mfma_f32_16x16x32_bf16 v[116:119], v[68:71], v[168:171], v[116:119]
    ds_read_b64_tr_b16 v[92:93], v28 offset:53248
    v_mfma_f32_16x16x32_bf16 v[120:123], v[72:75], v[168:171], v[120:123]
    ds_read_b64_tr_b16 v[94:95], v28 offset:55296
    v_mfma_f32_16x16x32_bf16 v[124:127], v[76:79], v[168:171], v[124:127]
    ds_read_b64_tr_b16 v[96:97], v29 offset:53248
    v_mfma_f32_16x16x32_bf16 v[128:131], v[80:83], v[168:171], v[128:131]
    ds_read_b64_tr_b16 v[98:99], v29 offset:55296
    s_add_u32 s71, s70, 32768
    buffer_load_dwordx4 v[168:171], v22, s[32:35], s71 offen offset:0 sc1
    s_waitcnt vmcnt(9) lgkmcnt(6)
    v_mfma_f32_16x16x32_bf16 v[100:103], v[84:87], v[172:175], v[100:103]
    ds_read_b64_tr_b16 v[68:69], v26 offset:57344
    s_waitcnt lgkmcnt(5)
    v_mfma_f32_16x16x32_bf16 v[104:107], v[88:91], v[172:175], v[104:107]
    ds_read_b64_tr_b16 v[70:71], v26 offset:59392
    s_waitcnt lgkmcnt(4)
    v_mfma_f32_16x16x32_bf16 v[108:111], v[92:95], v[172:175], v[108:111]
    ds_read_b64_tr_b16 v[72:73], v27 offset:57344
    s_waitcnt lgkmcnt(3)
    v_mfma_f32_16x16x32_bf16 v[112:115], v[96:99], v[172:175], v[112:115]
    ds_read_b64_tr_b16 v[74:75], v27 offset:59392
    buffer_load_dwordx4 v[172:175], v22, s[32:35], s70 offen offset:1024 sc1
    s_waitcnt vmcnt(9)
    v_mfma_f32_16x16x32_bf16 v[116:119], v[84:87], v[176:179], v[116:119]
    ds_read_b64_tr_b16 v[76:77], v28 offset:57344
    v_mfma_f32_16x16x32_bf16 v[120:123], v[88:91], v[176:179], v[120:123]
    ds_read_b64_tr_b16 v[78:79], v28 offset:59392
    v_mfma_f32_16x16x32_bf16 v[124:127], v[92:95], v[176:179], v[124:127]
    ds_read_b64_tr_b16 v[80:81], v29 offset:57344
    v_mfma_f32_16x16x32_bf16 v[128:131], v[96:99], v[176:179], v[128:131]
    ds_read_b64_tr_b16 v[82:83], v29 offset:59392
    buffer_load_dwordx4 v[176:179], v22, s[32:35], s71 offen offset:1024 sc1
    s_waitcnt vmcnt(9) lgkmcnt(6)
    v_mfma_f32_16x16x32_bf16 v[100:103], v[68:71], v[180:183], v[100:103]
    ds_read_b64_tr_b16 v[84:85], v26 offset:61440
    s_waitcnt lgkmcnt(5)
    v_mfma_f32_16x16x32_bf16 v[104:107], v[72:75], v[180:183], v[104:107]
    ds_read_b64_tr_b16 v[86:87], v26 offset:63488
    s_waitcnt lgkmcnt(4)
    v_mfma_f32_16x16x32_bf16 v[108:111], v[76:79], v[180:183], v[108:111]
    ds_read_b64_tr_b16 v[88:89], v27 offset:61440
    s_waitcnt lgkmcnt(3)
    v_mfma_f32_16x16x32_bf16 v[112:115], v[80:83], v[180:183], v[112:115]
    ds_read_b64_tr_b16 v[90:91], v27 offset:63488
    buffer_load_dwordx4 v[180:183], v22, s[32:35], s70 offen offset:2048 sc1
    s_waitcnt vmcnt(9)
    v_mfma_f32_16x16x32_bf16 v[116:119], v[68:71], v[184:187], v[116:119]
    ds_read_b64_tr_b16 v[92:93], v28 offset:61440
    v_mfma_f32_16x16x32_bf16 v[120:123], v[72:75], v[184:187], v[120:123]
    ds_read_b64_tr_b16 v[94:95], v28 offset:63488
    v_mfma_f32_16x16x32_bf16 v[124:127], v[76:79], v[184:187], v[124:127]
    ds_read_b64_tr_b16 v[96:97], v29 offset:61440
    v_mfma_f32_16x16x32_bf16 v[128:131], v[80:83], v[184:187], v[128:131]
    ds_read_b64_tr_b16 v[98:99], v29 offset:63488
    buffer_load_dwordx4 v[184:187], v22, s[32:35], s71 offen offset:2048 sc1
    v_add_u32 v26, 65536, v26
    v_add_u32 v27, 65536, v27
    v_add_u32 v28, 65536, v28
    v_add_u32 v29, 65536, v29
    s_waitcnt vmcnt(9) lgkmcnt(6)
    v_mfma_f32_16x16x32_bf16 v[100:103], v[84:87], v[188:191], v[100:103]
    ds_read_b64_tr_b16 v[68:69], v26 offset:0
    s_waitcnt lgkmcnt(5)
    v_mfma_f32_16x16x32_bf16 v[104:107], v[88:91], v[188:191], v[104:107]
    ds_read_b64_tr_b16 v[70:71], v26 offset:2048
    s_waitcnt lgkmcnt(4)
    v_mfma_f32_16x16x32_bf16 v[108:111], v[92:95], v[188:191], v[108:111]
    ds_read_b64_tr_b16 v[72:73], v27 offset:0
    s_waitcnt lgkmcnt(3)
    v_mfma_f32_16x16x32_bf16 v[112:115], v[96:99], v[188:191], v[112:115]
    ds_read_b64_tr_b16 v[74:75], v27 offset:2048
    buffer_load_dwordx4 v[188:191], v22, s[32:35], s70 offen offset:3072 sc1
    s_waitcnt vmcnt(9)
    v_mfma_f32_16x16x32_bf16 v[116:119], v[84:87], v[192:195], v[116:119]
    ds_read_b64_tr_b16 v[76:77], v28 offset:0
    v_mfma_f32_16x16x32_bf16 v[120:123], v[88:91], v[192:195], v[120:123]
    ds_read_b64_tr_b16 v[78:79], v28 offset:2048
    v_mfma_f32_16x16x32_bf16 v[124:127], v[92:95], v[192:195], v[124:127]
    ds_read_b64_tr_b16 v[80:81], v29 offset:0
    v_mfma_f32_16x16x32_bf16 v[128:131], v[96:99], v[192:195], v[128:131]
    ds_read_b64_tr_b16 v[82:83], v29 offset:2048
    buffer_load_dwordx4 v[192:195], v22, s[32:35], s71 offen offset:3072 sc1
    s_waitcnt vmcnt(7) lgkmcnt(6)
    v_mfma_f32_16x16x32_bf16 v[100:103], v[68:71], v[164:167], v[100:103]
    ds_read_b64_tr_b16 v[84:85], v26 offset:4096
    s_waitcnt lgkmcnt(5)
    v_mfma_f32_16x16x32_bf16 v[104:107], v[72:75], v[164:167], v[104:107]
    ds_read_b64_tr_b16 v[86:87], v26 offset:6144
    s_waitcnt lgkmcnt(4)
    v_mfma_f32_16x16x32_bf16 v[108:111], v[76:79], v[164:167], v[108:111]
    ds_read_b64_tr_b16 v[88:89], v27 offset:4096
    s_waitcnt lgkmcnt(3)
    v_mfma_f32_16x16x32_bf16 v[112:115], v[80:83], v[164:167], v[112:115]
    ds_read_b64_tr_b16 v[90:91], v27 offset:6144
    s_add_u32 s70, s44, 20480
    s_and_b32 s70, s70, 0x7fff
    buffer_load_dwordx4 v[164:167], v22, s[32:35], s70 offen offset:0 sc1
    s_waitcnt vmcnt(7)
    v_mfma_f32_16x16x32_bf16 v[116:119], v[68:71], v[168:171], v[116:119]
    ds_read_b64_tr_b16 v[92:93], v28 offset:4096
    v_mfma_f32_16x16x32_bf16 v[120:123], v[72:75], v[168:171], v[120:123]
    ds_read_b64_tr_b16 v[94:95], v28 offset:6144
    v_mfma_f32_16x16x32_bf16 v[124:127], v[76:79], v[168:171], v[124:127]
    ds_read_b64_tr_b16 v[96:97], v29 offset:4096
    v_mfma_f32_16x16x32_bf16 v[128:131], v[80:83], v[168:171], v[128:131]
    ds_read_b64_tr_b16 v[98:99], v29 offset:6144
    s_add_u32 s71, s70, 32768
    buffer_load_dwordx4 v[168:171], v22, s[32:35], s71 offen offset:0 sc1
    s_waitcnt vmcnt(7) lgkmcnt(6)
    v_mfma_f32_16x16x32_bf16 v[100:103], v[84:87], v[172:175], v[100:103]
    ds_read_b64_tr_b16 v[68:69], v26 offset:8192
    s_waitcnt lgkmcnt(5)
    v_mfma_f32_16x16x32_bf16 v[104:107], v[88:91], v[172:175], v[104:107]
    ds_read_b64_tr_b16 v[70:71], v26 offset:10240
    s_waitcnt lgkmcnt(4)
    v_mfma_f32_16x16x32_bf16 v[108:111], v[92:95], v[172:175], v[108:111]
    ds_read_b64_tr_b16 v[72:73], v27 offset:8192
    s_waitcnt lgkmcnt(3)
    v_mfma_f32_16x16x32_bf16 v[112:115], v[96:99], v[172:175], v[112:115]
    ds_read_b64_tr_b16 v[74:75], v27 offset:10240
    buffer_load_dwordx4 v[172:175], v22, s[32:35], s70 offen offset:1024 sc1
    s_waitcnt vmcnt(7)
    v_mfma_f32_16x16x32_bf16 v[116:119], v[84:87], v[176:179], v[116:119]
    ds_read_b64_tr_b16 v[76:77], v28 offset:8192
    v_mfma_f32_16x16x32_bf16 v[120:123], v[88:91], v[176:179], v[120:123]
    ds_read_b64_tr_b16 v[78:79], v28 offset:10240
    v_mfma_f32_16x16x32_bf16 v[124:127], v[92:95], v[176:179], v[124:127]
    ds_read_b64_tr_b16 v[80:81], v29 offset:8192
    v_mfma_f32_16x16x32_bf16 v[128:131], v[96:99], v[176:179], v[128:131]
    ds_read_b64_tr_b16 v[82:83], v29 offset:10240
    buffer_load_dwordx4 v[176:179], v22, s[32:35], s71 offen offset:1024 sc1
    s_waitcnt vmcnt(7) lgkmcnt(6)
    v_mfma_f32_16x16x32_bf16 v[100:103], v[68:71], v[180:183], v[100:103]
    ds_read_b64_tr_b16 v[84:85], v26 offset:12288
    s_waitcnt lgkmcnt(5)
    v_mfma_f32_16x16x32_bf16 v[104:107], v[72:75], v[180:183], v[104:107]
    ds_read_b64_tr_b16 v[86:87], v26 offset:14336
    s_waitcnt lgkmcnt(4)
    v_mfma_f32_16x16x32_bf16 v[108:111], v[76:79], v[180:183], v[108:111]
    ds_read_b64_tr_b16 v[88:89], v27 offset:12288
    s_waitcnt lgkmcnt(3)
    v_mfma_f32_16x16x32_bf16 v[112:115], v[80:83], v[180:183], v[112:115]
    ds_read_b64_tr_b16 v[90:91], v27 offset:14336
    buffer_load_dwordx4 v[180:183], v22, s[32:35], s70 offen offset:2048 sc1
    s_waitcnt vmcnt(7)
    v_mfma_f32_16x16x32_bf16 v[116:119], v[68:71], v[184:187], v[116:119]
    ds_read_b64_tr_b16 v[92:93], v28 offset:12288
    v_mfma_f32_16x16x32_bf16 v[120:123], v[72:75], v[184:187], v[120:123]
    ds_read_b64_tr_b16 v[94:95], v28 offset:14336
    v_mfma_f32_16x16x32_bf16 v[124:127], v[76:79], v[184:187], v[124:127]
    ds_read_b64_tr_b16 v[96:97], v29 offset:12288
    v_mfma_f32_16x16x32_bf16 v[128:131], v[80:83], v[184:187], v[128:131]
    ds_read_b64_tr_b16 v[98:99], v29 offset:14336
    buffer_load_dwordx4 v[184:187], v22, s[32:35], s71 offen offset:2048 sc1
    v_add_u32 v26, 4294852608, v26
    v_add_u32 v27, 4294852608, v27
    v_add_u32 v28, 4294852608, v28
    v_add_u32 v29, 4294852608, v29
    s_waitcnt vmcnt(7) lgkmcnt(6)
    v_mfma_f32_16x16x32_bf16 v[100:103], v[84:87], v[188:191], v[100:103]
    ds_read_b64_tr_b16 v[68:69], v26 offset:0
    s_waitcnt lgkmcnt(5)
    v_mfma_f32_16x16x32_bf16 v[104:107], v[88:91], v[188:191], v[104:107]
    ds_read_b64_tr_b16 v[70:71], v26 offset:2048
    s_waitcnt lgkmcnt(4)
    v_mfma_f32_16x16x32_bf16 v[108:111], v[92:95], v[188:191], v[108:111]
    ds_read_b64_tr_b16 v[72:73], v27 offset:0
    s_waitcnt lgkmcnt(3)
    v_mfma_f32_16x16x32_bf16 v[112:115], v[96:99], v[188:191], v[112:115]
    ds_read_b64_tr_b16 v[74:75], v27 offset:2048
    buffer_load_dwordx4 v[188:191], v22, s[32:35], s70 offen offset:3072 sc1
    s_waitcnt vmcnt(7)
    v_mfma_f32_16x16x32_bf16 v[116:119], v[84:87], v[192:195], v[116:119]
    ds_read_b64_tr_b16 v[76:77], v28 offset:0
    v_mfma_f32_16x16x32_bf16 v[120:123], v[88:91], v[192:195], v[120:123]
    ds_read_b64_tr_b16 v[78:79], v28 offset:2048
    v_mfma_f32_16x16x32_bf16 v[124:127], v[92:95], v[192:195], v[124:127]
    ds_read_b64_tr_b16 v[80:81], v29 offset:0
    v_mfma_f32_16x16x32_bf16 v[128:131], v[96:99], v[192:195], v[128:131]
    ds_read_b64_tr_b16 v[82:83], v29 offset:2048
    buffer_load_dwordx4 v[192:195], v22, s[32:35], s71 offen offset:3072 sc1
    ds_read_b128 v[64:67], v24
    s_waitcnt vmcnt(7) lgkmcnt(7)
    v_mfma_f32_16x16x32_bf16 v[100:103], v[68:71], v[164:167], v[100:103]
    ds_read_b64_tr_b16 v[84:85], v26 offset:4096
    s_waitcnt lgkmcnt(6)
    v_mfma_f32_16x16x32_bf16 v[104:107], v[72:75], v[164:167], v[104:107]
    ds_read_b64_tr_b16 v[86:87], v26 offset:6144
    s_waitcnt lgkmcnt(5)
    v_mfma_f32_16x16x32_bf16 v[108:111], v[76:79], v[164:167], v[108:111]
    ds_read_b64_tr_b16 v[88:89], v27 offset:4096
    s_waitcnt lgkmcnt(4)
    v_mfma_f32_16x16x32_bf16 v[112:115], v[80:83], v[164:167], v[112:115]
    ds_read_b64_tr_b16 v[90:91], v27 offset:6144
    s_add_u32 s70, s44, 24576
    s_and_b32 s70, s70, 0x7fff
    buffer_load_dwordx4 v[164:167], v22, s[32:35], s70 offen offset:0 sc1
    s_waitcnt vmcnt(7)
    v_mfma_f32_16x16x32_bf16 v[116:119], v[68:71], v[168:171], v[116:119]
    ds_read_b64_tr_b16 v[92:93], v28 offset:4096
    v_mfma_f32_16x16x32_bf16 v[120:123], v[72:75], v[168:171], v[120:123]
    ds_read_b64_tr_b16 v[94:95], v28 offset:6144
    v_mfma_f32_16x16x32_bf16 v[124:127], v[76:79], v[168:171], v[124:127]
    ds_read_b64_tr_b16 v[96:97], v29 offset:4096
    v_mfma_f32_16x16x32_bf16 v[128:131], v[80:83], v[168:171], v[128:131]
    ds_read_b64_tr_b16 v[98:99], v29 offset:6144
    s_add_u32 s71, s70, 32768
    buffer_load_dwordx4 v[168:171], v22, s[32:35], s71 offen offset:0 sc1
    s_waitcnt lgkmcnt(8)
    v_min_u32 v64, v64, v65
    v_min3_u32 v64, v64, v66, v67
    v_cmp_gt_u32 vcc, 2, v64
    s_cbranch_vccnz L_clf_17_slow
L_clf_17_back:
    s_waitcnt vmcnt(7) lgkmcnt(6)
    v_mfma_f32_16x16x32_bf16 v[100:103], v[84:87], v[172:175], v[100:103]
    ds_read_b64_tr_b16 v[68:69], v26 offset:8192
    s_waitcnt lgkmcnt(5)
    v_mfma_f32_16x16x32_bf16 v[104:107], v[88:91], v[172:175], v[104:107]
    ds_read_b64_tr_b16 v[70:71], v26 offset:10240
    s_waitcnt lgkmcnt(4)
    v_mfma_f32_16x16x32_bf16 v[108:111], v[92:95], v[172:175], v[108:111]
    ds_read_b64_tr_b16 v[72:73], v27 offset:8192
    s_waitcnt lgkmcnt(3)
    v_mfma_f32_16x16x32_bf16 v[112:115], v[96:99], v[172:175], v[112:115]
    ds_read_b64_tr_b16 v[74:75], v27 offset:10240
    buffer_load_dwordx4 v[172:175], v22, s[32:35], s70 offen offset:1024 sc1
    s_waitcnt vmcnt(7)
    v_mfma_f32_16x16x32_bf16 v[116:119], v[84:87], v[176:179], v[116:119]
    ds_read_b64_tr_b16 v[76:77], v28 offset:8192
    v_mfma_f32_16x16x32_bf16 v[120:123], v[88:91], v[176:179], v[120:123]
    ds_read_b64_tr_b16 v[78:79], v28 offset:10240
    v_mfma_f32_16x16x32_bf16 v[124:127], v[92:95], v[176:179], v[124:127]
    ds_read_b64_tr_b16 v[80:81], v29 offset:8192
    v_mfma_f32_16x16x32_bf16 v[128:131], v[96:99], v[176:179], v[128:131]
    ds_read_b64_tr_b16 v[82:83], v29 offset:10240
    buffer_load_dwordx4 v[176:179], v22, s[32:35], s71 offen offset:1024 sc1
    s_waitcnt vmcnt(7) lgkmcnt(6)
    v_mfma_f32_16x16x32_bf16 v[100:103], v[68:71], v[180:183], v[100:103]
    ds_read_b64_tr_b16 v[84:85], v26 offset:12288
    s_waitcnt lgkmcnt(5)
    v_mfma_f32_16x16x32_bf16 v[104:107], v[72:75], v[180:183], v[104:107]
    ds_read_b64_tr_b16 v[86:87], v26 offset:14336
    s_waitcnt lgkmcnt(4)
    v_mfma_f32_16x16x32_bf16 v[108:111], v[76:79], v[180:183], v[108:111]
    ds_read_b64_tr_b16 v[88:89], v27 offset:12288
    s_waitcnt lgkmcnt(3)
    v_mfma_f32_16x16x32_bf16 v[112:115], v[80:83], v[180:183], v[112:115]
    ds_read_b64_tr_b16 v[90:91], v27 offset:14336
    buffer_load_dwordx4 v[180:183], v22, s[32:35], s70 offen offset:2048 sc1
    s_waitcnt vmcnt(7)
    v_mfma_f32_16x16x32_bf16 v[116:119], v[68:71], v[184:187], v[116:119]
    ds_read_b64_tr_b16 v[92:93], v28 offset:12288
    v_mfma_f32_16x16x32_bf16 v[120:123], v[72:75], v[184:187], v[120:123]
    ds_read_b64_tr_b16 v[94:95], v28 offset:14336
    v_mfma_f32_16x16x32_bf16 v[124:127], v[76:79], v[184:187], v[124:127]
    ds_read_b64_tr_b16 v[96:97], v29 offset:12288
    v_mfma_f32_16x16x32_bf16 v[128:131], v[80:83], v[184:187], v[128:131]
    ds_read_b64_tr_b16 v[98:99], v29 offset:14336
    buffer_load_dwordx4 v[184:187], v22, s[32:35], s71 offen offset:2048 sc1
    s_waitcnt vmcnt(7) lgkmcnt(6)
    v_mfma_f32_16x16x32_bf16 v[100:103], v[84:87], v[188:191], v[100:103]
    ds_read_b64_tr_b16 v[68:69], v26 offset:16384
    s_waitcnt lgkmcnt(5)
    v_mfma_f32_16x16x32_bf16 v[104:107], v[88:91], v[188:191], v[104:107]
    ds_read_b64_tr_b16 v[70:71], v26 offset:18432
    s_waitcnt lgkmcnt(4)
    v_mfma_f32_16x16x32_bf16 v[108:111], v[92:95], v[188:191], v[108:111]
    ds_read_b64_tr_b16 v[72:73], v27 offset:16384
    s_waitcnt lgkmcnt(3)
    v_mfma_f32_16x16x32_bf16 v[112:115], v[96:99], v[188:191], v[112:115]
    ds_read_b64_tr_b16 v[74:75], v27 offset:18432
    buffer_load_dwordx4 v[188:191], v22, s[32:35], s70 offen offset:3072 sc1
    s_waitcnt vmcnt(7)
    v_mfma_f32_16x16x32_bf16 v[116:119], v[84:87], v[192:195], v[116:119]
    ds_read_b64_tr_b16 v[76:77], v28 offset:16384
    v_mfma_f32_16x16x32_bf16 v[120:123], v[88:91], v[192:195], v[120:123]
    ds_read_b64_tr_b16 v[78:79], v28 offset:18432
    v_mfma_f32_16x16x32_bf16 v[124:127], v[92:95], v[192:195], v[124:127]
    ds_read_b64_tr_b16 v[80:81], v29 offset:16384
    v_mfma_f32_16x16x32_bf16 v[128:131], v[96:99], v[192:195], v[128:131]
    ds_read_b64_tr_b16 v[82:83], v29 offset:18432
    buffer_load_dwordx4 v[192:195], v22, s[32:35], s71 offen offset:3072 sc1
    s_waitcnt vmcnt(7) lgkmcnt(6)
    v_mfma_f32_16x16x32_bf16 v[100:103], v[68:71], v[164:167], v[100:103]
    ds_read_b64_tr_b16 v[84:85], v26 offset:20480
    s_waitcnt lgkmcnt(5)
    v_mfma_f32_16x16x32_bf16 v[104:107], v[72:75], v[164:167], v[104:107]
    ds_read_b64_tr_b16 v[86:87], v26 offset:22528
    s_waitcnt lgkmcnt(4)
    v_mfma_f32_16x16x32_bf16 v[108:111], v[76:79], v[164:167], v[108:111]
    ds_read_b64_tr_b16 v[88:89], v27 offset:20480
    s_waitcnt lgkmcnt(3)
    v_mfma_f32_16x16x32_bf16 v[112:115], v[80:83], v[164:167], v[112:115]
    ds_read_b64_tr_b16 v[90:91], v27 offset:22528
    s_add_u32 s70, s44, 28672
    s_and_b32 s70, s70, 0x7fff
    buffer_load_dwordx4 v[164:167], v22, s[32:35], s70 offen offset:0 sc1
    s_waitcnt vmcnt(7)
    v_mfma_f32_16x16x32_bf16 v[116:119], v[68:71], v[168:171], v[116:119]
    ds_read_b64_tr_b16 v[92:93], v28 offset:20480
    v_mfma_f32_16x16x32_bf16 v[120:123], v[72:75], v[168:171], v[120:123]
    ds_read_b64_tr_b16 v[94:95], v28 offset:22528
    v_mfma_f32_16x16x32_bf16 v[124:127], v[76:79], v[168:171], v[124:127]
    ds_read_b64_tr_b16 v[96:97], v29 offset:20480
    v_mfma_f32_16x16x32_bf16 v[128:131], v[80:83], v[168:171], v[128:131]
    ds_read_b64_tr_b16 v[98:99], v29 offset:22528
    s_add_u32 s71, s70, 32768
    buffer_load_dwordx4 v[168:171], v22, s[32:35], s71 offen offset:0 sc1
    s_waitcnt vmcnt(7) lgkmcnt(6)
    v_mfma_f32_16x16x32_bf16 v[100:103], v[84:87], v[172:175], v[100:103]
    ds_read_b64_tr_b16 v[68:69], v26 offset:24576
    s_waitcnt lgkmcnt(5)
    v_mfma_f32_16x16x32_bf16 v[104:107], v[88:91], v[172:175], v[104:107]
    ds_read_b64_tr_b16 v[70:71], v26 offset:26624
    s_waitcnt lgkmcnt(4)
    v_mfma_f32_16x16x32_bf16 v[108:111], v[92:95], v[172:175], v[108:111]
    ds_read_b64_tr_b16 v[72:73], v27 offset:24576
    s_waitcnt lgkmcnt(3)
    v_mfma_f32_16x16x32_bf16 v[112:115], v[96:99], v[172:175], v[112:115]
    ds_read_b64_tr_b16 v[74:75], v27 offset:26624
    buffer_load_dwordx4 v[172:175], v22, s[32:35], s70 offen offset:1024 sc1
    s_waitcnt vmcnt(7)
    v_mfma_f32_16x16x32_bf16 v[116:119], v[84:87], v[176:179], v[116:119]
    ds_read_b64_tr_b16 v[76:77], v28 offset:24576
    v_mfma_f32_16x16x32_bf16 v[120:123], v[88:91], v[176:179], v[120:123]
    ds_read_b64_tr_b16 v[78:79], v28 offset:26624
    v_mfma_f32_16x16x32_bf16 v[124:127], v[92:95], v[176:179], v[124:127]
    ds_read_b64_tr_b16 v[80:81], v29 offset:24576
    v_mfma_f32_16x16x32_bf16 v[128:131], v[96:99], v[176:179], v[128:131]
    ds_read_b64_tr_b16 v[82:83], v29 offset:26624
    buffer_load_dwordx4 v[176:179], v22, s[32:35], s71 offen offset:1024 sc1
    s_waitcnt vmcnt(7) lgkmcnt(6)
    v_mfma_f32_16x16x32_bf16 v[100:103], v[68:71], v[180:183], v[100:103]
    ds_read_b64_tr_b16 v[84:85], v26 offset:28672
    s_waitcnt lgkmcnt(5)
    v_mfma_f32_16x16x32_bf16 v[104:107], v[72:75], v[180:183], v[104:107]
    ds_read_b64_tr_b16 v[86:87], v26 offset:30720
    s_waitcnt lgkmcnt(4)
    v_mfma_f32_16x16x32_bf16 v[108:111], v[76:79], v[180:183], v[108:111]
    ds_read_b64_tr_b16 v[88:89], v27 offset:28672
    s_waitcnt lgkmcnt(3)
    v_mfma_f32_16x16x32_bf16 v[112:115], v[80:83], v[180:183], v[112:115]
    ds_read_b64_tr_b16 v[90:91], v27 offset:30720
    buffer_load_dwordx4 v[180:183], v22, s[32:35], s70 offen offset:2048 sc1
    s_waitcnt vmcnt(7)
    v_mfma_f32_16x16x32_bf16 v[116:119], v[68:71], v[184:187], v[116:119]
    ds_read_b64_tr_b16 v[92:93], v28 offset:28672
    v_mfma_f32_16x16x32_bf16 v[120:123], v[72:75], v[184:187], v[120:123]
    ds_read_b64_tr_b16 v[94:95], v28 offset:30720
    v_mfma_f32_16x16x32_bf16 v[124:127], v[76:79], v[184:187], v[124:127]
    ds_read_b64_tr_b16 v[96:97], v29 offset:28672
    v_mfma_f32_16x16x32_bf16 v[128:131], v[80:83], v[184:187], v[128:131]
    ds_read_b64_tr_b16 v[98:99], v29 offset:30720
    buffer_load_dwordx4 v[184:187], v22, s[32:35], s71 offen offset:2048 sc1
    s_waitcnt vmcnt(7) lgkmcnt(6)
    v_mfma_f32_16x16x32_bf16 v[100:103], v[84:87], v[188:191], v[100:103]
    ds_read_b64_tr_b16 v[68:69], v26 offset:32768
    s_waitcnt lgkmcnt(5)
    v_mfma_f32_16x16x32_bf16 v[104:107], v[88:91], v[188:191], v[104:107]
    ds_read_b64_tr_b16 v[70:71], v26 offset:34816
    s_waitcnt lgkmcnt(4)
    v_mfma_f32_16x16x32_bf16 v[108:111], v[92:95], v[188:191], v[108:111]
    ds_read_b64_tr_b16 v[72:73], v27 offset:32768
    s_waitcnt lgkmcnt(3)
    v_mfma_f32_16x16x32_bf16 v[112:115], v[96:99], v[188:191], v[112:115]
    ds_read_b64_tr_b16 v[74:75], v27 offset:34816
    buffer_load_dwordx4 v[188:191], v22, s[32:35], s70 offen offset:3072 sc1
    s_waitcnt vmcnt(7)
    v_mfma_f32_16x16x32_bf16 v[116:119], v[84:87], v[192:195], v[116:119]
    ds_read_b64_tr_b16 v[76:77], v28 offset:32768
    v_mfma_f32_16x16x32_bf16 v[120:123], v[88:91], v[192:195], v[120:123]
    ds_read_b64_tr_b16 v[78:79], v28 offset:34816
    v_mfma_f32_16x16x32_bf16 v[124:127], v[92:95], v[192:195], v[124:127]
    ds_read_b64_tr_b16 v[80:81], v29 offset:32768
    v_mfma_f32_16x16x32_bf16 v[128:131], v[96:99], v[192:195], v[128:131]
    ds_read_b64_tr_b16 v[82:83], v29 offset:34816
    buffer_load_dwordx4 v[192:195], v22, s[32:35], s71 offen offset:3072 sc1
    s_waitcnt vmcnt(7) lgkmcnt(6)
    v_mfma_f32_16x16x32_bf16 v[100:103], v[68:71], v[164:167], v[100:103]
    ds_read_b64_tr_b16 v[84:85], v26 offset:36864
    s_waitcnt lgkmcnt(5)
    v_mfma_f32_16x16x32_bf16 v[104:107], v[72:75], v[164:167], v[104:107]
    ds_read_b64_tr_b16 v[86:87], v26 offset:38912
    s_waitcnt lgkmcnt(4)
    v_mfma_f32_16x16x32_bf16 v[108:111], v[76:79], v[164:167], v[108:111]
    ds_read_b64_tr_b16 v[88:89], v27 offset:36864
    s_waitcnt lgkmcnt(3)
    v_mfma_f32_16x16x32_bf16 v[112:115], v[80:83], v[164:167], v[112:115]
    ds_read_b64_tr_b16 v[90:91], v27 offset:38912
    s_waitcnt vmcnt(6)
    v_mfma_f32_16x16x32_bf16 v[116:119], v[68:71], v[168:171], v[116:119]
    ds_read_b64_tr_b16 v[92:93], v28 offset:36864
    v_mfma_f32_16x16x32_bf16 v[120:123], v[72:75], v[168:171], v[120:123]
    ds_read_b64_tr_b16 v[94:95], v28 offset:38912
    v_mfma_f32_16x16x32_bf16 v[124:127], v[76:79], v[168:171], v[124:127]
    ds_read_b64_tr_b16 v[96:97], v29 offset:36864
    v_mfma_f32_16x16x32_bf16 v[128:131], v[80:83], v[168:171], v[128:131]
    ds_read_b64_tr_b16 v[98:99], v29 offset:38912
    ds_read_b128 v[64:67], v24
    s_waitcnt vmcnt(5) lgkmcnt(7)
    v_mfma_f32_16x16x32_bf16 v[100:103], v[84:87], v[172:175], v[100:103]
    ds_read_b64_tr_b16 v[68:69], v26 offset:40960
    s_waitcnt lgkmcnt(6)
    v_mfma_f32_16x16x32_bf16 v[104:107], v[88:91], v[172:175], v[104:107]
    ds_read_b64_tr_b16 v[70:71], v26 offset:43008
    s_waitcnt lgkmcnt(5)
    v_mfma_f32_16x16x32_bf16 v[108:111], v[92:95], v[172:175], v[108:111]
    ds_read_b64_tr_b16 v[72:73], v27 offset:40960
    s_waitcnt lgkmcnt(4)
    v_mfma_f32_16x16x32_bf16 v[112:115], v[96:99], v[172:175], v[112:115]
    ds_read_b64_tr_b16 v[74:75], v27 offset:43008
    s_waitcnt vmcnt(4)
    v_mfma_f32_16x16x32_bf16 v[116:119], v[84:87], v[176:179], v[116:119]
    ds_read_b64_tr_b16 v[76:77], v28 offset:40960
    v_mfma_f32_16x16x32_bf16 v[120:123], v[88:91], v[176:179], v[120:123]
    ds_read_b64_tr_b16 v[78:79], v28 offset:43008
    v_mfma_f32_16x16x32_bf16 v[124:127], v[92:95], v[176:179], v[124:127]
    ds_read_b64_tr_b16 v[80:81], v29 offset:40960
    v_mfma_f32_16x16x32_bf16 v[128:131], v[96:99], v[176:179], v[128:131]
    ds_read_b64_tr_b16 v[82:83], v29 offset:43008
    v_max_u32 v1, v60, v61
    v_cmp_eq_u32 vcc, -1, v1
    s_cbranch_vccnz L_gv_18_slow
L_gv_18:
    s_waitcnt lgkmcnt(8)
    v_min_u32 v64, v64, v65
    v_min3_u32 v64, v64, v66, v67
    v_cmp_gt_u32 vcc, 3, v64
    s_cbranch_vccnz L_clf_19_slow
L_clf_19_back:
    ds_read_b64_tr_b16 v[42:43], v30 offset:0
    ds_read_b64_tr_b16 v[44:45], v30 offset:4608
    ds_read_b64_tr_b16 v[46:47], v30 offset:9216
    ds_read_b64_tr_b16 v[48:49], v30 offset:13824
    ds_read_b64_tr_b16 v[50:51], v31 offset:0
    ds_read_b64_tr_b16 v[52:53], v31 offset:4608
    ds_read_b64_tr_b16 v[54:55], v31 offset:9216
    ds_read_b64_tr_b16 v[56:57], v31 offset:13824
    s_waitcnt vmcnt(3) lgkmcnt(14)
    v_mfma_f32_16x16x32_bf16 v[100:103], v[68:71], v[180:183], v[100:103]
    ds_read_b64_tr_b16 v[84:85], v26 offset:45056
    s_waitcnt lgkmcnt(13)
    v_mfma_f32_16x16x32_bf16 v[104:107], v[72:75], v[180:183], v[104:107]
    ds_read_b64_tr_b16 v[86:87], v26 offset:47104
    s_waitcnt lgkmcnt(12)
    v_mfma_f32_16x16x32_bf16 v[108:111], v[76:79], v[180:183], v[108:111]
    ds_read_b64_tr_b16 v[88:89], v27 offset:45056
    s_waitcnt lgkmcnt(11)
    v_mfma_f32_16x16x32_bf16 v[112:115], v[80:83], v[180:183], v[112:115]
    ds_read_b64_tr_b16 v[90:91], v27 offset:47104
    s_waitcnt vmcnt(2)
    v_mfma_f32_16x16x32_bf16 v[116:119], v[68:71], v[184:187], v[116:119]
    ds_read_b64_tr_b16 v[92:93], v28 offset:45056
    v_mfma_f32_16x16x32_bf16 v[120:123], v[72:75], v[184:187], v[120:123]
    ds_read_b64_tr_b16 v[94:95], v28 offset:47104
    v_mfma_f32_16x16x32_bf16 v[124:127], v[76:79], v[184:187], v[124:127]
    ds_read_b64_tr_b16 v[96:97], v29 offset:45056
    v_mfma_f32_16x16x32_bf16 v[128:131], v[80:83], v[184:187], v[128:131]
    ds_read_b64_tr_b16 v[98:99], v29 offset:47104
    s_waitcnt vmcnt(1) lgkmcnt(6)
    v_mfma_f32_16x16x32_bf16 v[100:103], v[84:87], v[188:191], v[100:103]
    v_sub_f32 v62, 1.0, v60
    v_cvt_pk_bf16_f32 v62, v62, v62
    v_lshlrev_b32 v62, 16, v62
    v_lshlrev_b32 v132, 16, v42
    v_and_b32 v133, 0xffff0000, v42
    v_lshlrev_b32 v134, 16, v43
    v_and_b32 v135, 0xffff0000, v43
    v_mul_f32 v132, v60, v132
    s_waitcnt lgkmcnt(4)
    v_mfma_f32_16x16x32_bf16 v[104:107], v[88:91], v[188:191], v[104:107]
    v_mul_f32 v133, v60, v133
    v_mul_f32 v134, v60, v134
    v_mul_f32 v135, v60, v135
    v_lshlrev_b32 v136, 16, v44
    v_and_b32 v137, 0xffff0000, v44
    v_lshlrev_b32 v138, 16, v45
    v_and_b32 v139, 0xffff0000, v45
    v_mul_f32 v136, v60, v136
    v_mul_f32 v137, v60, v137
    s_waitcnt lgkmcnt(2)
    v_mfma_f32_16x16x32_bf16 v[108:111], v[92:95], v[188:191], v[108:111]
    v_mul_f32 v138, v60, v138
    v_mul_f32 v139, v60, v139
    v_lshlrev_b32 v140, 16, v46
    v_and_b32 v141, 0xffff0000, v46
    v_lshlrev_b32 v142, 16, v47
    v_and_b32 v143, 0xffff0000, v47
    v_mul_f32 v140, v60, v140
    v_mul_f32 v141, v60, v141
    v_mul_f32 v142, v60, v142
    s_waitcnt lgkmcnt(0)
    v_mfma_f32_16x16x32_bf16 v[112:115], v[96:99], v[188:191], v[112:115]
    v_mul_f32 v143, v60, v143
    v_lshlrev_b32 v144, 16, v48
    v_and_b32 v145, 0xffff0000, v48
    v_lshlrev_b32 v146, 16, v49
    v_and_b32 v147, 0xffff0000, v49
    v_mul_f32 v144, v60, v144
    v_mul_f32 v145, v60, v145
    v_mul_f32 v146, v60, v146
    v_mul_f32 v147, v60, v147
    s_waitcnt vmcnt(0)
    v_mfma_f32_16x16x32_bf16 v[116:119], v[84:87], v[192:195], v[116:119]
    v_sub_f32 v63, 1.0, v61
    v_cvt_pk_bf16_f32 v63, v63, v63
    v_lshlrev_b32 v63, 16, v63
    v_lshlrev_b32 v148, 16, v50
    v_and_b32 v149, 0xffff0000, v50
    v_lshlrev_b32 v150, 16, v51
    v_and_b32 v151, 0xffff0000, v51
    v_mul_f32 v148, v61, v148
    v_mfma_f32_16x16x32_bf16 v[120:123], v[88:91], v[192:195], v[120:123]
    v_mul_f32 v149, v61, v149
    v_mul_f32 v150, v61, v150
    v_mul_f32 v151, v61, v151
    v_lshlrev_b32 v152, 16, v52
    v_and_b32 v153, 0xffff0000, v52
    v_lshlrev_b32 v154, 16, v53
    v_and_b32 v155, 0xffff0000, v53
    v_mul_f32 v152, v61, v152
    v_mul_f32 v153, v61, v153
    v_mfma_f32_16x16x32_bf16 v[124:127], v[92:95], v[192:195], v[124:127]
    v_mul_f32 v154, v61, v154
    v_mul_f32 v155, v61, v155
    v_lshlrev_b32 v156, 16, v54
    v_and_b32 v157, 0xffff0000, v54
    v_lshlrev_b32 v158, 16, v55
    v_and_b32 v159, 0xffff0000, v55
    v_mul_f32 v156, v61, v156
    v_mul_f32 v157, v61, v157
    v_mul_f32 v158, v61, v158
    v_mfma_f32_16x16x32_bf16 v[128:131], v[96:99], v[192:195], v[128:131]
    v_mul_f32 v159, v61, v159
    v_lshlrev_b32 v160, 16, v56
    v_and_b32 v161, 0xffff0000, v56
    v_lshlrev_b32 v162, 16, v57
    v_and_b32 v163, 0xffff0000, v57
    v_mul_f32 v160, v61, v160
    v_mul_f32 v161, v61, v161
    v_mul_f32 v162, v61, v162
    v_mul_f32 v163, v61, v163
    v_fmac_f32 v132, v62, v100
    v_fmac_f32 v133, v62, v101
    v_fmac_f32 v134, v62, v102
    v_fmac_f32 v135, v62, v103
    v_cvt_pk_bf16_f32 v164, v132, v133
    v_cvt_pk_bf16_f32 v165, v134, v135
    v_fmac_f32 v136, v62, v104
    v_fmac_f32 v137, v62, v105
    v_fmac_f32 v138, v62, v106
    v_fmac_f32 v139, v62, v107
    v_cvt_pk_bf16_f32 v166, v136, v137
    v_cvt_pk_bf16_f32 v167, v138, v139
    s_mov_b32 s58, 0
    v_permlane16_swap_b32 v164, v166
    v_permlane16_swap_b32 v165, v167
    buffer_store_dwordx4 v[164:167], v25, s[48:51], s58 offen offset:0
    v_fmac_f32 v140, v62, v108
    v_fmac_f32 v141, v62, v109
    v_fmac_f32 v142, v62, v110
    v_fmac_f32 v143, v62, v111
    v_cvt_pk_bf16_f32 v168, v140, v141
    v_cvt_pk_bf16_f32 v169, v142, v143
    v_fmac_f32 v144, v62, v112
    v_fmac_f32 v145, v62, v113
    v_fmac_f32 v146, v62, v114
    v_fmac_f32 v147, v62, v115
    v_cvt_pk_bf16_f32 v170, v144, v145
    v_cvt_pk_bf16_f32 v171, v146, v147
    s_mov_b32 s58, 0
    v_permlane16_swap_b32 v168, v170
    v_permlane16_swap_b32 v169, v171
    buffer_store_dwordx4 v[168:171], v25, s[48:51], s58 offen offset:64
    v_fmac_f32 v148, v63, v116
    v_fmac_f32 v149, v63, v117
    v_fmac_f32 v150, v63, v118
    v_fmac_f32 v151, v63, v119
    v_cvt_pk_bf16_f32 v172, v148, v149
    v_cvt_pk_bf16_f32 v173, v150, v151
    v_fmac_f32 v152, v63, v120
    v_fmac_f32 v153, v63, v121
    v_fmac_f32 v154, v63, v122
    v_fmac_f32 v155, v63, v123
    v_cvt_pk_bf16_f32 v174, v152, v153
    v_cvt_pk_bf16_f32 v175, v154, v155
    s_mov_b32 s58, 32768
    v_permlane16_swap_b32 v172, v174
    v_permlane16_swap_b32 v173, v175
    buffer_store_dwordx4 v[172:175], v25, s[48:51], s58 offen offset:0
    v_fmac_f32 v156, v63, v124
    v_fmac_f32 v157, v63, v125
    v_fmac_f32 v158, v63, v126
    v_fmac_f32 v159, v63, v127
    v_cvt_pk_bf16_f32 v176, v156, v157
    v_cvt_pk_bf16_f32 v177, v158, v159
    v_fmac_f32 v160, v63, v128
    v_fmac_f32 v161, v63, v129
    v_fmac_f32 v162, v63, v130
    v_fmac_f32 v163, v63, v131
    v_cvt_pk_bf16_f32 v178, v160, v161
    v_cvt_pk_bf16_f32 v179, v162, v163
    s_mov_b32 s58, 32768
    v_permlane16_swap_b32 v176, v178
    v_permlane16_swap_b32 v177, v179
    buffer_store_dwordx4 v[176:179], v25, s[48:51], s58 offen offset:64
L_end:
    s_endpgm
L_eslow:
    s_mov_b32 s43, 0
L_poll_5:
    s_sleep 32
    buffer_load_dword v20, v21, s[64:67], 0 offen sc1
    s_add_u32 s43, s43, 1
    s_cmp_gt_u32 s43, 40000
    s_waitcnt vmcnt(0)
    s_cbranch_scc1 L_polld_6
    v_cmp_gt_u32 vcc, 64, v20
    s_cbranch_vccnz L_poll_5
L_polld_6:
    s_branch L_eback
L_gat_10_slow:
    s_mov_b64 exec, 1
    s_mov_b32 s43, 0
    v_mov_b32 v8, 0
    buffer_atomic_add v8, v4, s[32:35], 0 offen sc0 sc1
L_pc_11:
    s_sleep 2
    v_mov_b32 v9, 0
    buffer_atomic_add v9, v4, s[32:35], 0 offen sc0 sc1
    s_waitcnt vmcnt(1)
    v_cmp_gt_u32 vcc, 32, v8
    s_cbranch_vccz L_gat_10_ok
    s_sleep 2
    v_mov_b32 v8, 0
    buffer_atomic_add v8, v4, s[32:35], 0 offen sc0 sc1
    s_add_u32 s43, s43, 1
    s_waitcnt vmcnt(1)
    v_cmp_gt_u32 vcc, 32, v9
    s_cbranch_vccz L_gat_10_ok
    s_cmp_lt_u32 s43, 40000
    s_cbranch_scc1 L_pc_11
L_gat_10_ok:
    s_mov_b64 exec, -1
    s_branch L_gat_10
L_clf_17_slow:
    s_mov_b32 s43, 0
L_clf_17_spin:
    ds_read_b128 v[64:67], v24
    s_add_u32 s43, s43, 1
    s_cmp_gt_u32 s43, 400000
    s_waitcnt lgkmcnt(0)
    s_cbranch_scc1 L_clf_17_back
    v_min_u32 v64, v64, v65
    v_min3_u32 v64, v64, v66, v67
    v_cmp_gt_u32 vcc, 2, v64
    s_cbranch_vccnz L_clf_17_spin
    s_branch L_clf_17_back
L_gv_18_slow:
    s_mov_b32 s43, 0
L_gv_18_spin:
    buffer_load_dword v60, v23, s[32:35], 0 offen sc1
    buffer_load_dword v61, v23, s[32:35], 0 offen offset:64 sc1
    s_add_u32 s43, s43, 1
    s_cmp_gt_u32 s43, 40000
    s_waitcnt vmcnt(0)
    s_cbranch_scc1 L_gv_18
    v_max_u32 v1, v60, v61
    v_cmp_eq_u32 vcc, -1, v1
    s_cbranch_vccnz L_gv_18_spin
    s_branch L_gv_18
L_clf_19_slow:
    s_mov_b32 s43, 0
L_clf_19_spin:
    ds_read_b128 v[64:67], v24
    s_add_u32 s43, s43, 1
    s_cmp_gt_u32 s43, 400000
    s_waitcnt lgkmcnt(0)
    s_cbranch_scc1 L_clf_19_back
    v_min_u32 v64, v64, v65
    v_min3_u32 v64, v64, v66, v67
    v_cmp_gt_u32 vcc, 3, v64
    s_cbranch_vccnz L_clf_19_spin
    s_branch L_clf_19_back
L_codeend:
.section .rodata,"a"
.p2align 6
.amdhsa_kernel gated_mix__ssm_conv_s4d__linear_attn_block__prompt_kernel
  .amdhsa_next_free_vgpr 256
  .amdhsa_next_free_sgpr 102
  .amdhsa_accum_offset 256
  .amdhsa_group_segment_fixed_size 0
  .amdhsa_kernarg_size 112
  .amdhsa_user_sgpr_count 2
  .amdhsa_user_sgpr_kernarg_segment_ptr 1
  .amdhsa_system_sgpr_workgroup_id_x 1
  .amdhsa_float_denorm_mode_32 3
  .amdhsa_float_denorm_mode_16_64 3
.end_amdhsa_kernel
```
